```python
import torch

def _softmax(x, axis=-1):
    return torch.softmax(x, dim=axis)

def _gelu(x):
    return torch.nn.functional.gelu(x, approximate='tanh')

def _silu(x):
    return torch.nn.functional.silu(x)

def _sigmoid(x):
    return torch.sigmoid(x)

def _layernorm(x, axis=-1, eps=1e-05):
    m = x.mean(dim=axis, keepdim=True)
    v = x.var(dim=axis, keepdim=True, unbiased=False)
    return (x - m) / torch.sqrt(v + eps)

def _scatter_add(tgt, idx, src, axis=0):
    return tgt.clone().index_add_(axis, idx, src)

def _segment_sum(src, seg, n):
    out = torch.zeros((n,) + src.shape[1:], dtype=src.dtype)
    return out.index_add_(0, seg, src)

def _pad(x, pw):
    flat = tuple((v for pair in reversed(pw) for v in pair))
    return torch.nn.functional.pad(x, flat)
kernel_name = 'adaLN_cond__gqa_block_cached__dense_activation_relu__decode'

def setup_inputs():

    _w = lambda a: (lambda t: t.to(torch.bfloat16) if t.is_floating_point() else t)(torch.as_tensor(a))

    def _A_setup():
        B, Sq, D = (8, 1, 576)
        Hq, Hkv, Sk, Dh = (32, 16, 4096, 128)
        assert Hq % Hkv == 0, (Hq, Hkv)
        return {'x': _w((lambda *s: torch.randn(*s, dtype=torch.bfloat16) * 0.05)(B, Sq, D)), 'k_cache': _w((lambda *s: torch.randn(*s, dtype=torch.bfloat16) * 3.2)(B, Hkv, Sk, Dh)), 'v_cache': _w((lambda *s: torch.randn(*s, dtype=torch.bfloat16) * 0.4)(B, Hkv, Sk, Dh)), 'wq': _w((lambda *s: torch.randn(*s, dtype=torch.bfloat16) * 3.2)(D, Hq * Dh) * D ** (-0.5)), 'wo': _w((lambda *s: torch.randn(*s, dtype=torch.bfloat16) * 0.4)(Hq * Dh, D) * (Hq * Dh) ** (-0.5))}
    _A_in = _A_setup()

    def _B_setup():
        B, S, D, Dff = (8, 1, 576, 4608)
        return {'x': _w((lambda *s: torch.randn(*s, dtype=torch.bfloat16) * 0.05)(B, S, D)), 'w1': _w((lambda *s: torch.randn(*s, dtype=torch.bfloat16) * 0.05)(D, Dff)), 'w2': _w((lambda *s: torch.randn(*s, dtype=torch.bfloat16) * 0.05)(Dff, D))}
    _B_in = _B_setup()
    return {'A_x': _A_in['x'], 'A_k_cache': _A_in['k_cache'], 'A_v_cache': _A_in['v_cache'], 'A_wq': _A_in['wq'], 'A_wo': _A_in['wo'], 'B_x': _B_in['x'], 'B_w1': _B_in['w1'], 'B_w2': _B_in['w2'], 'c': _w((lambda *s: torch.randn(*s, dtype=torch.bfloat16) * 0.2)(8, 576) * 8.0), 'w_mod': _w((lambda *s: torch.randn(*s, dtype=torch.bfloat16) * 0.2)(576, 6 * 576) * 576 ** (-0.5) * 8.0)}

def reference(A_x, A_k_cache, A_v_cache, A_wq, A_wo, B_x, B_w1, B_w2, c, w_mod):

    def _A_ref(x, k_cache, v_cache, wq, wo):
        B, Sq, D = x.shape
        Hq, Dh = (32, 128)
        Hkv = k_cache.shape[1]
        rep = Hq // Hkv
        q = (lambda x, *d: x.permute(*d))((x @ wq).reshape(B, Sq, Hq, Dh), 0, 2, 1, 3)
        k = (lambda x, n, axis: torch.repeat_interleave(x, n, dim=axis))(k_cache, rep, axis=1)
        v = (lambda x, n, axis: torch.repeat_interleave(x, n, dim=axis))(v_cache, rep, axis=1)
        scores = torch.einsum('bhqd,bhkd->bhqk', q, k) * Dh ** (-0.5)
        p = _softmax(scores, axis=-1)
        o = torch.einsum('bhqk,bhkd->bhqd', p, v)
        return (lambda x, *d: x.permute(*d))(o, 0, 2, 1, 3).reshape(B, Sq, Hq * Dh) @ wo

    def _B_ref(x, w1, w2):
        h = torch.einsum('bsd,df->bsf', x, w1)
        zero = torch.zeros_like(h)
        h = torch.maximum(h, zero)
        return torch.einsum('bsf,fd->bsd', h, w2)
    x = A_x
    mod = (_silu(c) @ w_mod).reshape(c.shape[0], 6, 1, -1)
    sa, ca, ga, sb, cb, gb = (mod[:, 0].clone(), mod[:, 1].clone(), mod[:, 2].clone(), mod[:, 3].clone(), mod[:, 4].clone(), mod[:, 5].clone())
    h = _layernorm(x, axis=-1) * (1 + ca) + sa
    x = x + ga * _A_ref(h, A_k_cache, A_v_cache, A_wq, A_wo)
    h = _layernorm(x, axis=-1) * (1 + cb) + sb
    x = x + gb * _B_ref(h, B_w1, B_w2)
    return x
```

```asm
; @launch grid=(256,1,1) block=(512,1,1) lds=163840
.amdgcn_target "amdgcn-amd-amdhsa--gfx950"
.text
.globl adaLN_cond__gqa_block_cached__dense_activation_relu__decode_kernel
.p2align 8
.type adaLN_cond__gqa_block_cached__dense_activation_relu__decode_kernel,@function
adaLN_cond__gqa_block_cached__dense_activation_relu__decode_kernel:
  s_cmp_ge_u32 s2, 256
  s_cbranch_scc1 L_end
  s_load_dwordx16 s[16:31], s[0:1], 0
  s_load_dwordx2 s[40:41], s[0:1], 96
  s_load_dwordx8 s[32:39], s[0:1], 64
  v_lshrrev_b32 v1, 6, v0
  s_and_b32 s8, s2, 7
  v_readfirstlane_b32 s3, v1
  s_lshl_b32 s8, s8, 2
  s_lshr_b32 s8, 1460888608, s8
  s_and_b32 s8, s8, 7
  s_andn2_b32 s4, s2, 7
  s_or_b32 s4, s4, s8
  s_lshr_b32 s5, s4, 1
  s_and_b32 s6, s4, 1
  s_bfe_u32 s13, s2, 0x10003
  s_mov_b64 s[42:43], -1
  v_and_b32 v4, 63, v0
  s_cmp_ge_u32 s3, 4
  s_cbranch_scc1 L_ctrl
  v_bfe_u32 v5, v4, 2, 2
  v_lshlrev_b32 v5, 8, v5
  v_lshrrev_b32 v6, 4, v4
  v_lshlrev_b32 v6, 6, v6
  v_and_b32 v1, 3, v4
  v_lshlrev_b32 v1, 4, v1
  v_add3_u32 v1, v1, v5, v6
  v_lshlrev_b32 v2, 4, v4
  s_lshl_b32 s8, s3, 12
  v_add_u32 v1, s8, v1
  v_add_u32 v2, s8, v2
  s_cmp_eq_u32 s13, s6
  s_cselect_b32 s11, 1, 0
  s_cselect_b32 s12, 4, 4
  s_lshl_b32 s78, 1, s12
  s_sub_u32 s78, s78, 1
  s_sub_u32 s12, 8, s12
  s_mul_i32 s12, s12, s6
  s_lshl_b32 s78, s78, s12
  s_cmp_lt_u32 s5, 72
  s_cselect_b32 s83, s11, 1
  s_cselect_b32 s78, s78, 0xff
  s_cmp_eq_u32 s6, 0
  s_cselect_b32 s84, 1, -1
  s_cselect_b32 s11, 0, 31
  s_lshl_b32 s85, s11, 15
  s_lshl_b32 s84, s84, 15
  s_lshl_b32 s9, s5, 20
  s_mov_b32 s10, s85
  s_waitcnt lgkmcnt(0)
  s_add_u32 s44, s18, s9
  s_addc_u32 s45, s19, 0
  s_mov_b32 s46, 1048576
  s_mov_b32 s47, 0x20000
  buffer_load_dwordx4 v[32:35], v1, s[44:47], s10 offen offset:0 nt
  buffer_load_dwordx4 v[36:39], v1, s[44:47], s10 offen offset:1024 nt
  buffer_load_dwordx4 v[40:43], v1, s[44:47], s10 offen offset:2048 nt
  buffer_load_dwordx4 v[44:47], v1, s[44:47], s10 offen offset:3072 nt
  s_barrier
  s_add_u32 s11, s10, 16384
  buffer_load_dwordx4 v[48:51], v1, s[44:47], s11 offen offset:0 nt
  s_waitcnt vmcnt(4)
  buffer_load_dwordx4 v[52:55], v1, s[44:47], s11 offen offset:1024 nt
  s_waitcnt vmcnt(4)
  buffer_load_dwordx4 v[56:59], v1, s[44:47], s11 offen offset:2048 nt
  s_waitcnt vmcnt(4)
  buffer_load_dwordx4 v[60:63], v1, s[44:47], s11 offen offset:3072 nt
  s_add_u32 s10, s10, s84
  s_add_u32 s48, s20, s9
  s_addc_u32 s49, s21, 0
  s_mov_b32 s50, 1048576
  s_mov_b32 s51, 0x20000
  s_mov_b32 s52, s40
  s_mov_b32 s53, s41
  s_mov_b32 s54, 16777216
  s_mov_b32 s55, 0x20000
  s_mov_b32 s60, 0x22222222
  s_mov_b32 s61, 0x22222222
  s_mov_b32 s62, 0x88888888
  s_mov_b32 s63, 0x88888888
  s_mov_b32 s64, 0xcccccccc
  s_mov_b32 s65, 0xcccccccc
  s_cmp_eq_u32 s83, 1
  s_cselect_b32 s79, s78, 0xff
  s_mov_b32 s80, 0
  s_bitcmp0_b32 s78, 0
  s_cselect_b32 s8, 0x11111111, 0
  s_or_b32 s80, s80, s8
  s_bitcmp0_b32 s78, 2
  s_cselect_b32 s8, 0x22222222, 0
  s_or_b32 s80, s80, s8
  s_bitcmp0_b32 s78, 4
  s_cselect_b32 s8, 0x44444444, 0
  s_or_b32 s80, s80, s8
  s_bitcmp0_b32 s78, 6
  s_cselect_b32 s8, 0x88888888, 0
  s_or_b32 s80, s80, s8
  s_mov_b32 s81, s80
  v_mov_b32 v6, 0
  v_mov_b32 v6, 160328
  v_mov_b32 v5, 1
  s_waitcnt vmcnt(4)
  buffer_load_dwordx4 v[64:67], v1, s[44:47], s10 offen offset:0 nt
  s_waitcnt vmcnt(4)
  buffer_load_dwordx4 v[68:71], v1, s[44:47], s10 offen offset:1024 nt
  s_waitcnt vmcnt(4)
  buffer_load_dwordx4 v[72:75], v1, s[44:47], s10 offen offset:2048 nt
  s_waitcnt vmcnt(4)
  buffer_load_dwordx4 v[76:79], v1, s[44:47], s10 offen offset:3072 nt
  s_add_u32 s11, s10, 16384
  s_waitcnt vmcnt(4)
  buffer_load_dwordx4 v[80:83], v1, s[44:47], s11 offen offset:0 nt
  s_waitcnt vmcnt(4)
  buffer_load_dwordx4 v[84:87], v1, s[44:47], s11 offen offset:1024 nt
  s_waitcnt vmcnt(4)
  buffer_load_dwordx4 v[88:91], v1, s[44:47], s11 offen offset:2048 nt
  s_waitcnt vmcnt(4)
  buffer_load_dwordx4 v[92:95], v1, s[44:47], s11 offen offset:3072 nt
  s_add_u32 s10, s10, s84
  s_waitcnt vmcnt(4)
  buffer_load_dwordx4 v[96:99], v1, s[44:47], s10 offen offset:0 nt
  s_waitcnt vmcnt(4)
  buffer_load_dwordx4 v[100:103], v1, s[44:47], s10 offen offset:1024 nt
  s_waitcnt vmcnt(4)
  buffer_load_dwordx4 v[104:107], v1, s[44:47], s10 offen offset:2048 nt
  s_waitcnt vmcnt(4)
  buffer_load_dwordx4 v[108:111], v1, s[44:47], s10 offen offset:3072 nt
  s_add_u32 s11, s10, 16384
  s_waitcnt vmcnt(4)
  buffer_load_dwordx4 v[112:115], v1, s[44:47], s11 offen offset:0 nt
  s_waitcnt vmcnt(4)
  buffer_load_dwordx4 v[116:119], v1, s[44:47], s11 offen offset:1024 nt
  s_waitcnt vmcnt(4)
  buffer_load_dwordx4 v[120:123], v1, s[44:47], s11 offen offset:2048 nt
  s_waitcnt vmcnt(4)
  buffer_load_dwordx4 v[124:127], v1, s[44:47], s11 offen offset:3072 nt
  s_add_u32 s10, s10, s84
  s_waitcnt vmcnt(4)
  buffer_load_dwordx4 v[128:131], v1, s[44:47], s10 offen offset:0 nt
  s_waitcnt vmcnt(4)
  buffer_load_dwordx4 v[132:135], v1, s[44:47], s10 offen offset:1024 nt
  s_waitcnt vmcnt(4)
  buffer_load_dwordx4 v[136:139], v1, s[44:47], s10 offen offset:2048 nt
  s_waitcnt vmcnt(4)
  buffer_load_dwordx4 v[140:143], v1, s[44:47], s10 offen offset:3072 nt
  s_add_u32 s11, s10, 16384
  s_waitcnt vmcnt(4)
  buffer_load_dwordx4 v[144:147], v1, s[44:47], s11 offen offset:0 nt
  s_waitcnt vmcnt(4)
  buffer_load_dwordx4 v[148:151], v1, s[44:47], s11 offen offset:1024 nt
  s_waitcnt vmcnt(4)
  buffer_load_dwordx4 v[152:155], v1, s[44:47], s11 offen offset:2048 nt
  s_waitcnt vmcnt(4)
  buffer_load_dwordx4 v[156:159], v1, s[44:47], s11 offen offset:3072 nt
  s_add_u32 s10, s10, s84
  s_waitcnt vmcnt(4)
  buffer_load_dwordx4 v[160:163], v1, s[44:47], s10 offen offset:0 nt
  s_waitcnt vmcnt(4)
  buffer_load_dwordx4 v[164:167], v1, s[44:47], s10 offen offset:1024 nt
  s_waitcnt vmcnt(4)
  buffer_load_dwordx4 v[168:171], v1, s[44:47], s10 offen offset:2048 nt
  s_waitcnt vmcnt(4)
  buffer_load_dwordx4 v[172:175], v1, s[44:47], s10 offen offset:3072 nt
  s_add_u32 s11, s10, 16384
  s_waitcnt vmcnt(4)
  buffer_load_dwordx4 v[176:179], v1, s[44:47], s11 offen offset:0 nt
  s_waitcnt vmcnt(4)
  buffer_load_dwordx4 v[180:183], v1, s[44:47], s11 offen offset:1024 nt
  s_waitcnt vmcnt(4)
  buffer_load_dwordx4 v[184:187], v1, s[44:47], s11 offen offset:2048 nt
  s_waitcnt vmcnt(4)
  buffer_load_dwordx4 v[188:191], v1, s[44:47], s11 offen offset:3072 nt
  s_add_u32 s10, s10, s84
  s_waitcnt vmcnt(4)
  buffer_load_dwordx4 v[192:195], v1, s[44:47], s10 offen offset:0 nt
  s_waitcnt vmcnt(4)
  buffer_load_dwordx4 v[196:199], v1, s[44:47], s10 offen offset:1024 nt
  s_waitcnt vmcnt(4)
  buffer_load_dwordx4 v[200:203], v1, s[44:47], s10 offen offset:2048 nt
  s_waitcnt vmcnt(4)
  buffer_load_dwordx4 v[204:207], v1, s[44:47], s10 offen offset:3072 nt
  s_add_u32 s11, s10, 16384
  s_waitcnt vmcnt(4)
  buffer_load_dwordx4 v[208:211], v1, s[44:47], s11 offen offset:0 nt
  s_waitcnt vmcnt(4)
  buffer_load_dwordx4 v[212:215], v1, s[44:47], s11 offen offset:1024 nt
  s_waitcnt vmcnt(4)
  buffer_load_dwordx4 v[216:219], v1, s[44:47], s11 offen offset:2048 nt
  s_waitcnt vmcnt(4)
  buffer_load_dwordx4 v[220:223], v1, s[44:47], s11 offen offset:3072 nt
  s_add_u32 s10, s10, s84
  s_waitcnt vmcnt(4)
  buffer_load_dwordx4 v[224:227], v1, s[44:47], s10 offen offset:0 nt
  s_waitcnt vmcnt(4)
  buffer_load_dwordx4 v[228:231], v1, s[44:47], s10 offen offset:1024 nt
  s_waitcnt vmcnt(4)
  buffer_load_dwordx4 v[232:235], v1, s[44:47], s10 offen offset:2048 nt
  s_waitcnt vmcnt(4)
  buffer_load_dwordx4 v[236:239], v1, s[44:47], s10 offen offset:3072 nt
  s_add_u32 s11, s10, 16384
  s_waitcnt vmcnt(4)
  buffer_load_dwordx4 v[240:243], v1, s[44:47], s11 offen offset:0 nt
  s_waitcnt vmcnt(4)
  buffer_load_dwordx4 v[244:247], v1, s[44:47], s11 offen offset:1024 nt
  s_waitcnt vmcnt(4)
  buffer_load_dwordx4 v[248:251], v1, s[44:47], s11 offen offset:2048 nt
  s_waitcnt vmcnt(4)
  buffer_load_dwordx4 v[252:255], v1, s[44:47], s11 offen offset:3072 nt
  s_add_u32 s10, s10, s84
  ds_write_b32 v6, v5 offset:4
  s_mov_b32 s92, 2400000
L_qwait:
  ds_read_b32 v5, v6
  s_waitcnt lgkmcnt(0)
  v_readfirstlane_b32 s8, v5
  s_nop 1
  s_cmp_lg_u32 s8, 0
  s_cbranch_scc1 L_qok
  s_sub_u32 s92, s92, 1
  s_cbranch_scc1 L_qok
  s_sleep 1
  s_branch L_qwait
L_qok:
  v_bfe_u32 v5, v4, 3, 1
  v_lshlrev_b32 v5, 8, v5
  v_lshrrev_b32 v6, 4, v4
  v_lshlrev_b32 v6, 6, v6
  v_and_b32 v16, 3, v4
  v_lshlrev_b32 v16, 4, v16
  v_add3_u32 v5, v5, v6, v16
  v_add_u32 v5, 159744, v5
  v_mov_b32 v6, 160256
  ds_read_b128 v[16:19], v5
  ds_read_b32 v3, v6
  v_and_b32 v20, 4, v4
  v_cmp_eq_u32 vcc, 0, v20
  s_mov_b32 s12, 1035273459
  s_waitcnt lgkmcnt(0)
  v_cndmask_b32 v8, 0, v16, vcc
  v_cndmask_b32 v9, 0, v17, vcc
  v_cndmask_b32 v10, 0, v18, vcc
  v_cndmask_b32 v11, 0, v19, vcc
  v_sub_u32 v12, v16, v8
  v_sub_u32 v13, v17, v9
  v_sub_u32 v14, v18, v10
  v_sub_u32 v15, v19, v11
  v_mfma_f32_16x16x32_bf16 v[16:19], v[8:11], v[32:35], 0
  v_mfma_f32_16x16x32_bf16 v[20:23], v[8:11], v[40:43], 0
  v_mfma_f32_16x16x32_bf16 v[24:27], v[8:11], v[48:51], 0
  v_mfma_f32_16x16x32_bf16 v[28:31], v[8:11], v[56:59], 0
  v_mfma_f32_16x16x32_bf16 v[16:19], v[12:15], v[36:39], v[16:19]
  v_mfma_f32_16x16x32_bf16 v[20:23], v[12:15], v[44:47], v[20:23]
  v_mfma_f32_16x16x32_bf16 v[24:27], v[12:15], v[52:55], v[24:27]
  v_mfma_f32_16x16x32_bf16 v[28:31], v[12:15], v[60:63], v[28:31]
  s_nop 4
  v_mov_b32_dpp v48, v16 quad_perm:[0,0,0,0] row_mask:0xf bank_mask:0xf
  v_mov_b32_dpp v49, v20 quad_perm:[0,0,0,0] row_mask:0xf bank_mask:0xf
  v_mov_b32_dpp v50, v24 quad_perm:[0,0,0,0] row_mask:0xf bank_mask:0xf
  v_mov_b32_dpp v51, v28 quad_perm:[0,0,0,0] row_mask:0xf bank_mask:0xf
  v_add_f32_dpp v48, v17, v48 quad_perm:[1,1,1,1] row_mask:0xf bank_mask:0xf
  v_add_f32_dpp v49, v21, v49 quad_perm:[1,1,1,1] row_mask:0xf bank_mask:0xf
  v_add_f32_dpp v50, v25, v50 quad_perm:[1,1,1,1] row_mask:0xf bank_mask:0xf
  v_add_f32_dpp v51, v29, v51 quad_perm:[1,1,1,1] row_mask:0xf bank_mask:0xf
  v_add_f32_dpp v48, v18, v48 quad_perm:[2,2,2,2] row_mask:0xf bank_mask:0xf
  v_add_f32_dpp v49, v22, v49 quad_perm:[2,2,2,2] row_mask:0xf bank_mask:0xf
  v_add_f32_dpp v50, v26, v50 quad_perm:[2,2,2,2] row_mask:0xf bank_mask:0xf
  v_add_f32_dpp v51, v30, v51 quad_perm:[2,2,2,2] row_mask:0xf bank_mask:0xf
  v_add_f32_dpp v48, v19, v48 quad_perm:[3,3,3,3] row_mask:0xf bank_mask:0xf
  v_add_f32_dpp v49, v23, v49 quad_perm:[3,3,3,3] row_mask:0xf bank_mask:0xf
  v_add_f32_dpp v50, v27, v50 quad_perm:[3,3,3,3] row_mask:0xf bank_mask:0xf
  v_add_f32_dpp v51, v31, v51 quad_perm:[3,3,3,3] row_mask:0xf bank_mask:0xf
  v_cndmask_b32 v48, v48, v49, s[60:61]
  v_cndmask_b32 v50, v50, v51, s[62:63]
  v_cndmask_b32 v48, v48, v50, s[64:65]
  v_cvt_pk_bf16_f32 v48, v48, v48
  v_lshlrev_b32 v48, 16, v48
  v_mul_f32 v48, s12, v48
  v_cvt_pk_bf16_f32 v32, v48, v48
  v_lshlrev_b32 v32, 16, v32
  v_mfma_f32_16x16x32_bf16 v[16:19], v[8:11], v[64:67], 0
  v_mfma_f32_16x16x32_bf16 v[20:23], v[8:11], v[72:75], 0
  v_mfma_f32_16x16x32_bf16 v[24:27], v[8:11], v[80:83], 0
  v_mfma_f32_16x16x32_bf16 v[28:31], v[8:11], v[88:91], 0
  v_mfma_f32_16x16x32_bf16 v[16:19], v[12:15], v[68:71], v[16:19]
  v_mfma_f32_16x16x32_bf16 v[20:23], v[12:15], v[76:79], v[20:23]
  v_mfma_f32_16x16x32_bf16 v[24:27], v[12:15], v[84:87], v[24:27]
  v_mfma_f32_16x16x32_bf16 v[28:31], v[12:15], v[92:95], v[28:31]
  s_waitcnt vmcnt(7)
  buffer_load_dwordx4 v[64:67], v1, s[44:47], s10 offen offset:0 nt
  s_nop 2
  v_mov_b32_dpp v48, v16 quad_perm:[0,0,0,0] row_mask:0xf bank_mask:0xf
  v_mov_b32_dpp v49, v20 quad_perm:[0,0,0,0] row_mask:0xf bank_mask:0xf
  v_mov_b32_dpp v50, v24 quad_perm:[0,0,0,0] row_mask:0xf bank_mask:0xf
  v_mov_b32_dpp v51, v28 quad_perm:[0,0,0,0] row_mask:0xf bank_mask:0xf
  v_add_f32_dpp v48, v17, v48 quad_perm:[1,1,1,1] row_mask:0xf bank_mask:0xf
  v_add_f32_dpp v49, v21, v49 quad_perm:[1,1,1,1] row_mask:0xf bank_mask:0xf
  v_add_f32_dpp v50, v25, v50 quad_perm:[1,1,1,1] row_mask:0xf bank_mask:0xf
  v_add_f32_dpp v51, v29, v51 quad_perm:[1,1,1,1] row_mask:0xf bank_mask:0xf
  v_add_f32_dpp v48, v18, v48 quad_perm:[2,2,2,2] row_mask:0xf bank_mask:0xf
  v_add_f32_dpp v49, v22, v49 quad_perm:[2,2,2,2] row_mask:0xf bank_mask:0xf
  v_add_f32_dpp v50, v26, v50 quad_perm:[2,2,2,2] row_mask:0xf bank_mask:0xf
  s_waitcnt vmcnt(7)
  buffer_load_dwordx4 v[68:71], v1, s[44:47], s10 offen offset:1024 nt
  v_add_f32_dpp v51, v30, v51 quad_perm:[2,2,2,2] row_mask:0xf bank_mask:0xf
  v_add_f32_dpp v48, v19, v48 quad_perm:[3,3,3,3] row_mask:0xf bank_mask:0xf
  v_add_f32_dpp v49, v23, v49 quad_perm:[3,3,3,3] row_mask:0xf bank_mask:0xf
  v_add_f32_dpp v50, v27, v50 quad_perm:[3,3,3,3] row_mask:0xf bank_mask:0xf
  v_add_f32_dpp v51, v31, v51 quad_perm:[3,3,3,3] row_mask:0xf bank_mask:0xf
  v_cndmask_b32 v48, v48, v49, s[60:61]
  v_cndmask_b32 v50, v50, v51, s[62:63]
  v_cndmask_b32 v48, v48, v50, s[64:65]
  v_cvt_pk_bf16_f32 v48, v48, v48
  v_lshlrev_b32 v48, 16, v48
  v_mul_f32 v48, s12, v48
  s_waitcnt vmcnt(7)
  buffer_load_dwordx4 v[72:75], v1, s[44:47], s10 offen offset:2048 nt
  v_cvt_pk_bf16_f32 v33, v48, v48
  v_lshlrev_b32 v33, 16, v33
  v_mfma_f32_16x16x32_bf16 v[16:19], v[8:11], v[96:99], 0
  v_mfma_f32_16x16x32_bf16 v[20:23], v[8:11], v[104:107], 0
  v_mfma_f32_16x16x32_bf16 v[24:27], v[8:11], v[112:115], 0
  v_mfma_f32_16x16x32_bf16 v[28:31], v[8:11], v[120:123], 0
  v_mfma_f32_16x16x32_bf16 v[16:19], v[12:15], v[100:103], v[16:19]
  v_mfma_f32_16x16x32_bf16 v[20:23], v[12:15], v[108:111], v[20:23]
  v_mfma_f32_16x16x32_bf16 v[24:27], v[12:15], v[116:119], v[24:27]
  v_mfma_f32_16x16x32_bf16 v[28:31], v[12:15], v[124:127], v[28:31]
  s_nop 4
  v_mov_b32_dpp v48, v16 quad_perm:[0,0,0,0] row_mask:0xf bank_mask:0xf
  s_waitcnt vmcnt(7)
  buffer_load_dwordx4 v[76:79], v1, s[44:47], s10 offen offset:3072 nt
  v_mov_b32_dpp v49, v20 quad_perm:[0,0,0,0] row_mask:0xf bank_mask:0xf
  v_mov_b32_dpp v50, v24 quad_perm:[0,0,0,0] row_mask:0xf bank_mask:0xf
  v_mov_b32_dpp v51, v28 quad_perm:[0,0,0,0] row_mask:0xf bank_mask:0xf
  v_add_f32_dpp v48, v17, v48 quad_perm:[1,1,1,1] row_mask:0xf bank_mask:0xf
  v_add_f32_dpp v49, v21, v49 quad_perm:[1,1,1,1] row_mask:0xf bank_mask:0xf
  v_add_f32_dpp v50, v25, v50 quad_perm:[1,1,1,1] row_mask:0xf bank_mask:0xf
  v_add_f32_dpp v51, v29, v51 quad_perm:[1,1,1,1] row_mask:0xf bank_mask:0xf
  v_add_f32_dpp v48, v18, v48 quad_perm:[2,2,2,2] row_mask:0xf bank_mask:0xf
  v_add_f32_dpp v49, v22, v49 quad_perm:[2,2,2,2] row_mask:0xf bank_mask:0xf
  v_add_f32_dpp v50, v26, v50 quad_perm:[2,2,2,2] row_mask:0xf bank_mask:0xf
  v_add_f32_dpp v51, v30, v51 quad_perm:[2,2,2,2] row_mask:0xf bank_mask:0xf
  s_add_u32 s11, s10, 16384
  s_waitcnt vmcnt(7)
  buffer_load_dwordx4 v[80:83], v1, s[44:47], s11 offen offset:0 nt
  v_add_f32_dpp v48, v19, v48 quad_perm:[3,3,3,3] row_mask:0xf bank_mask:0xf
  v_add_f32_dpp v49, v23, v49 quad_perm:[3,3,3,3] row_mask:0xf bank_mask:0xf
  v_add_f32_dpp v50, v27, v50 quad_perm:[3,3,3,3] row_mask:0xf bank_mask:0xf
  v_add_f32_dpp v51, v31, v51 quad_perm:[3,3,3,3] row_mask:0xf bank_mask:0xf
  v_cndmask_b32 v48, v48, v49, s[60:61]
  v_cndmask_b32 v50, v50, v51, s[62:63]
  v_cndmask_b32 v48, v48, v50, s[64:65]
  v_cvt_pk_bf16_f32 v48, v48, v48
  v_lshlrev_b32 v48, 16, v48
  v_mul_f32 v48, s12, v48
  v_cvt_pk_bf16_f32 v34, v48, v48
  s_waitcnt vmcnt(7)
  buffer_load_dwordx4 v[84:87], v1, s[44:47], s11 offen offset:1024 nt
  v_lshlrev_b32 v34, 16, v34
  v_mfma_f32_16x16x32_bf16 v[16:19], v[8:11], v[128:131], 0
  v_mfma_f32_16x16x32_bf16 v[20:23], v[8:11], v[136:139], 0
  v_mfma_f32_16x16x32_bf16 v[24:27], v[8:11], v[144:147], 0
  v_mfma_f32_16x16x32_bf16 v[28:31], v[8:11], v[152:155], 0
  v_mfma_f32_16x16x32_bf16 v[16:19], v[12:15], v[132:135], v[16:19]
  v_mfma_f32_16x16x32_bf16 v[20:23], v[12:15], v[140:143], v[20:23]
  v_mfma_f32_16x16x32_bf16 v[24:27], v[12:15], v[148:151], v[24:27]
  v_mfma_f32_16x16x32_bf16 v[28:31], v[12:15], v[156:159], v[28:31]
  s_nop 4
  v_mov_b32_dpp v48, v16 quad_perm:[0,0,0,0] row_mask:0xf bank_mask:0xf
  v_mov_b32_dpp v49, v20 quad_perm:[0,0,0,0] row_mask:0xf bank_mask:0xf
  s_waitcnt vmcnt(7)
  buffer_load_dwordx4 v[88:91], v1, s[44:47], s11 offen offset:2048 nt
  v_mov_b32_dpp v50, v24 quad_perm:[0,0,0,0] row_mask:0xf bank_mask:0xf
  v_mov_b32_dpp v51, v28 quad_perm:[0,0,0,0] row_mask:0xf bank_mask:0xf
  v_add_f32_dpp v48, v17, v48 quad_perm:[1,1,1,1] row_mask:0xf bank_mask:0xf
  v_add_f32_dpp v49, v21, v49 quad_perm:[1,1,1,1] row_mask:0xf bank_mask:0xf
  v_add_f32_dpp v50, v25, v50 quad_perm:[1,1,1,1] row_mask:0xf bank_mask:0xf
  v_add_f32_dpp v51, v29, v51 quad_perm:[1,1,1,1] row_mask:0xf bank_mask:0xf
  v_add_f32_dpp v48, v18, v48 quad_perm:[2,2,2,2] row_mask:0xf bank_mask:0xf
  v_add_f32_dpp v49, v22, v49 quad_perm:[2,2,2,2] row_mask:0xf bank_mask:0xf
  v_add_f32_dpp v50, v26, v50 quad_perm:[2,2,2,2] row_mask:0xf bank_mask:0xf
  v_add_f32_dpp v51, v30, v51 quad_perm:[2,2,2,2] row_mask:0xf bank_mask:0xf
  v_add_f32_dpp v48, v19, v48 quad_perm:[3,3,3,3] row_mask:0xf bank_mask:0xf
  s_waitcnt vmcnt(7)
  buffer_load_dwordx4 v[92:95], v1, s[44:47], s11 offen offset:3072 nt
  v_add_f32_dpp v49, v23, v49 quad_perm:[3,3,3,3] row_mask:0xf bank_mask:0xf
  v_add_f32_dpp v50, v27, v50 quad_perm:[3,3,3,3] row_mask:0xf bank_mask:0xf
  v_add_f32_dpp v51, v31, v51 quad_perm:[3,3,3,3] row_mask:0xf bank_mask:0xf
  v_cndmask_b32 v48, v48, v49, s[60:61]
  v_cndmask_b32 v50, v50, v51, s[62:63]
  v_cndmask_b32 v48, v48, v50, s[64:65]
  v_cvt_pk_bf16_f32 v48, v48, v48
  v_lshlrev_b32 v48, 16, v48
  v_mul_f32 v48, s12, v48
  v_cvt_pk_bf16_f32 v35, v48, v48
  v_lshlrev_b32 v35, 16, v35
  s_add_u32 s10, s10, s84
  s_waitcnt vmcnt(7)
  buffer_load_dwordx4 v[96:99], v1, s[44:47], s10 offen offset:0 nt
  v_mfma_f32_16x16x32_bf16 v[16:19], v[8:11], v[160:163], 0
  v_mfma_f32_16x16x32_bf16 v[20:23], v[8:11], v[168:171], 0
  v_mfma_f32_16x16x32_bf16 v[24:27], v[8:11], v[176:179], 0
  v_mfma_f32_16x16x32_bf16 v[28:31], v[8:11], v[184:187], 0
  v_mfma_f32_16x16x32_bf16 v[16:19], v[12:15], v[164:167], v[16:19]
  v_mfma_f32_16x16x32_bf16 v[20:23], v[12:15], v[172:175], v[20:23]
  v_mfma_f32_16x16x32_bf16 v[24:27], v[12:15], v[180:183], v[24:27]
  v_mfma_f32_16x16x32_bf16 v[28:31], v[12:15], v[188:191], v[28:31]
  s_waitcnt vmcnt(7)
  buffer_load_dwordx4 v[100:103], v1, s[44:47], s10 offen offset:1024 nt
  s_nop 2
  v_mov_b32_dpp v48, v16 quad_perm:[0,0,0,0] row_mask:0xf bank_mask:0xf
  v_mov_b32_dpp v49, v20 quad_perm:[0,0,0,0] row_mask:0xf bank_mask:0xf
  v_mov_b32_dpp v50, v24 quad_perm:[0,0,0,0] row_mask:0xf bank_mask:0xf
  v_mov_b32_dpp v51, v28 quad_perm:[0,0,0,0] row_mask:0xf bank_mask:0xf
  v_add_f32_dpp v48, v17, v48 quad_perm:[1,1,1,1] row_mask:0xf bank_mask:0xf
  v_add_f32_dpp v49, v21, v49 quad_perm:[1,1,1,1] row_mask:0xf bank_mask:0xf
  v_add_f32_dpp v50, v25, v50 quad_perm:[1,1,1,1] row_mask:0xf bank_mask:0xf
  v_add_f32_dpp v51, v29, v51 quad_perm:[1,1,1,1] row_mask:0xf bank_mask:0xf
  s_waitcnt vmcnt(7)
  buffer_load_dwordx4 v[104:107], v1, s[44:47], s10 offen offset:2048 nt
  v_add_f32_dpp v48, v18, v48 quad_perm:[2,2,2,2] row_mask:0xf bank_mask:0xf
  v_add_f32_dpp v49, v22, v49 quad_perm:[2,2,2,2] row_mask:0xf bank_mask:0xf
  v_add_f32_dpp v50, v26, v50 quad_perm:[2,2,2,2] row_mask:0xf bank_mask:0xf
  v_add_f32_dpp v51, v30, v51 quad_perm:[2,2,2,2] row_mask:0xf bank_mask:0xf
  v_add_f32_dpp v48, v19, v48 quad_perm:[3,3,3,3] row_mask:0xf bank_mask:0xf
  v_add_f32_dpp v49, v23, v49 quad_perm:[3,3,3,3] row_mask:0xf bank_mask:0xf
  v_add_f32_dpp v50, v27, v50 quad_perm:[3,3,3,3] row_mask:0xf bank_mask:0xf
  v_add_f32_dpp v51, v31, v51 quad_perm:[3,3,3,3] row_mask:0xf bank_mask:0xf
  s_waitcnt vmcnt(7)
  buffer_load_dwordx4 v[108:111], v1, s[44:47], s10 offen offset:3072 nt
  v_cndmask_b32 v48, v48, v49, s[60:61]
  v_cndmask_b32 v50, v50, v51, s[62:63]
  v_cndmask_b32 v48, v48, v50, s[64:65]
  v_cvt_pk_bf16_f32 v48, v48, v48
  v_lshlrev_b32 v48, 16, v48
  v_mul_f32 v48, s12, v48
  v_cvt_pk_bf16_f32 v36, v48, v48
  v_lshlrev_b32 v36, 16, v36
  s_add_u32 s11, s10, 16384
  s_waitcnt vmcnt(7)
  buffer_load_dwordx4 v[112:115], v1, s[44:47], s11 offen offset:0 nt
  v_mfma_f32_16x16x32_bf16 v[16:19], v[8:11], v[192:195], 0
  v_mfma_f32_16x16x32_bf16 v[20:23], v[8:11], v[200:203], 0
  v_mfma_f32_16x16x32_bf16 v[24:27], v[8:11], v[208:211], 0
  v_mfma_f32_16x16x32_bf16 v[28:31], v[8:11], v[216:219], 0
  v_mfma_f32_16x16x32_bf16 v[16:19], v[12:15], v[196:199], v[16:19]
  v_mfma_f32_16x16x32_bf16 v[20:23], v[12:15], v[204:207], v[20:23]
  v_mfma_f32_16x16x32_bf16 v[24:27], v[12:15], v[212:215], v[24:27]
  v_mfma_f32_16x16x32_bf16 v[28:31], v[12:15], v[220:223], v[28:31]
  s_waitcnt vmcnt(7)
  buffer_load_dwordx4 v[116:119], v1, s[44:47], s11 offen offset:1024 nt
  s_nop 2
  v_mov_b32_dpp v48, v16 quad_perm:[0,0,0,0] row_mask:0xf bank_mask:0xf
  v_mov_b32_dpp v49, v20 quad_perm:[0,0,0,0] row_mask:0xf bank_mask:0xf
  v_mov_b32_dpp v50, v24 quad_perm:[0,0,0,0] row_mask:0xf bank_mask:0xf
  v_mov_b32_dpp v51, v28 quad_perm:[0,0,0,0] row_mask:0xf bank_mask:0xf
  v_add_f32_dpp v48, v17, v48 quad_perm:[1,1,1,1] row_mask:0xf bank_mask:0xf
  v_add_f32_dpp v49, v21, v49 quad_perm:[1,1,1,1] row_mask:0xf bank_mask:0xf
  v_add_f32_dpp v50, v25, v50 quad_perm:[1,1,1,1] row_mask:0xf bank_mask:0xf
  v_add_f32_dpp v51, v29, v51 quad_perm:[1,1,1,1] row_mask:0xf bank_mask:0xf
  s_waitcnt vmcnt(7)
  buffer_load_dwordx4 v[120:123], v1, s[44:47], s11 offen offset:2048 nt
  v_add_f32_dpp v48, v18, v48 quad_perm:[2,2,2,2] row_mask:0xf bank_mask:0xf
  v_add_f32_dpp v49, v22, v49 quad_perm:[2,2,2,2] row_mask:0xf bank_mask:0xf
  v_add_f32_dpp v50, v26, v50 quad_perm:[2,2,2,2] row_mask:0xf bank_mask:0xf
  v_add_f32_dpp v51, v30, v51 quad_perm:[2,2,2,2] row_mask:0xf bank_mask:0xf
  v_add_f32_dpp v48, v19, v48 quad_perm:[3,3,3,3] row_mask:0xf bank_mask:0xf
  v_add_f32_dpp v49, v23, v49 quad_perm:[3,3,3,3] row_mask:0xf bank_mask:0xf
  v_add_f32_dpp v50, v27, v50 quad_perm:[3,3,3,3] row_mask:0xf bank_mask:0xf
  v_add_f32_dpp v51, v31, v51 quad_perm:[3,3,3,3] row_mask:0xf bank_mask:0xf
  s_waitcnt vmcnt(7)
  buffer_load_dwordx4 v[124:127], v1, s[44:47], s11 offen offset:3072 nt
  v_cndmask_b32 v48, v48, v49, s[60:61]
  v_cndmask_b32 v50, v50, v51, s[62:63]
  v_cndmask_b32 v48, v48, v50, s[64:65]
  v_cvt_pk_bf16_f32 v48, v48, v48
  v_lshlrev_b32 v48, 16, v48
  v_mul_f32 v48, s12, v48
  v_cvt_pk_bf16_f32 v37, v48, v48
  v_lshlrev_b32 v37, 16, v37
  s_add_u32 s10, s10, s84
  s_waitcnt vmcnt(7)
  buffer_load_dwordx4 v[128:131], v1, s[44:47], s10 offen offset:0 nt
  v_mfma_f32_16x16x32_bf16 v[16:19], v[8:11], v[224:227], 0
  v_mfma_f32_16x16x32_bf16 v[20:23], v[8:11], v[232:235], 0
  v_mfma_f32_16x16x32_bf16 v[24:27], v[8:11], v[240:243], 0
  v_mfma_f32_16x16x32_bf16 v[28:31], v[8:11], v[248:251], 0
  v_mfma_f32_16x16x32_bf16 v[16:19], v[12:15], v[228:231], v[16:19]
  v_mfma_f32_16x16x32_bf16 v[20:23], v[12:15], v[236:239], v[20:23]
  v_mfma_f32_16x16x32_bf16 v[24:27], v[12:15], v[244:247], v[24:27]
  v_mfma_f32_16x16x32_bf16 v[28:31], v[12:15], v[252:255], v[28:31]
  s_waitcnt vmcnt(7)
  buffer_load_dwordx4 v[132:135], v1, s[44:47], s10 offen offset:1024 nt
  s_nop 2
  v_mov_b32_dpp v48, v16 quad_perm:[0,0,0,0] row_mask:0xf bank_mask:0xf
  v_mov_b32_dpp v49, v20 quad_perm:[0,0,0,0] row_mask:0xf bank_mask:0xf
  v_mov_b32_dpp v50, v24 quad_perm:[0,0,0,0] row_mask:0xf bank_mask:0xf
  v_mov_b32_dpp v51, v28 quad_perm:[0,0,0,0] row_mask:0xf bank_mask:0xf
  v_add_f32_dpp v48, v17, v48 quad_perm:[1,1,1,1] row_mask:0xf bank_mask:0xf
  v_add_f32_dpp v49, v21, v49 quad_perm:[1,1,1,1] row_mask:0xf bank_mask:0xf
  v_add_f32_dpp v50, v25, v50 quad_perm:[1,1,1,1] row_mask:0xf bank_mask:0xf
  v_add_f32_dpp v51, v29, v51 quad_perm:[1,1,1,1] row_mask:0xf bank_mask:0xf
  s_waitcnt vmcnt(7)
  buffer_load_dwordx4 v[136:139], v1, s[44:47], s10 offen offset:2048 nt
  v_add_f32_dpp v48, v18, v48 quad_perm:[2,2,2,2] row_mask:0xf bank_mask:0xf
  v_add_f32_dpp v49, v22, v49 quad_perm:[2,2,2,2] row_mask:0xf bank_mask:0xf
  v_add_f32_dpp v50, v26, v50 quad_perm:[2,2,2,2] row_mask:0xf bank_mask:0xf
  v_add_f32_dpp v51, v30, v51 quad_perm:[2,2,2,2] row_mask:0xf bank_mask:0xf
  v_add_f32_dpp v48, v19, v48 quad_perm:[3,3,3,3] row_mask:0xf bank_mask:0xf
  v_add_f32_dpp v49, v23, v49 quad_perm:[3,3,3,3] row_mask:0xf bank_mask:0xf
  v_add_f32_dpp v50, v27, v50 quad_perm:[3,3,3,3] row_mask:0xf bank_mask:0xf
  v_add_f32_dpp v51, v31, v51 quad_perm:[3,3,3,3] row_mask:0xf bank_mask:0xf
  s_waitcnt vmcnt(7)
  buffer_load_dwordx4 v[140:143], v1, s[44:47], s10 offen offset:3072 nt
  v_cndmask_b32 v48, v48, v49, s[60:61]
  v_cndmask_b32 v50, v50, v51, s[62:63]
  v_cndmask_b32 v48, v48, v50, s[64:65]
  v_cvt_pk_bf16_f32 v48, v48, v48
  v_lshlrev_b32 v48, 16, v48
  v_mul_f32 v48, s12, v48
  v_cvt_pk_bf16_f32 v38, v48, v48
  v_lshlrev_b32 v38, 16, v38
  s_add_u32 s11, s10, 16384
  s_waitcnt vmcnt(7)
  buffer_load_dwordx4 v[144:147], v1, s[44:47], s11 offen offset:0 nt
  v_mfma_f32_16x16x32_bf16 v[16:19], v[8:11], v[64:67], 0
  v_mfma_f32_16x16x32_bf16 v[20:23], v[8:11], v[72:75], 0
  v_mfma_f32_16x16x32_bf16 v[24:27], v[8:11], v[80:83], 0
  v_mfma_f32_16x16x32_bf16 v[28:31], v[8:11], v[88:91], 0
  v_mfma_f32_16x16x32_bf16 v[16:19], v[12:15], v[68:71], v[16:19]
  v_mfma_f32_16x16x32_bf16 v[20:23], v[12:15], v[76:79], v[20:23]
  v_mfma_f32_16x16x32_bf16 v[24:27], v[12:15], v[84:87], v[24:27]
  v_mfma_f32_16x16x32_bf16 v[28:31], v[12:15], v[92:95], v[28:31]
  s_waitcnt vmcnt(7)
  buffer_load_dwordx4 v[148:151], v1, s[44:47], s11 offen offset:1024 nt
  s_nop 2
  v_mov_b32_dpp v48, v16 quad_perm:[0,0,0,0] row_mask:0xf bank_mask:0xf
  v_mov_b32_dpp v49, v20 quad_perm:[0,0,0,0] row_mask:0xf bank_mask:0xf
  v_mov_b32_dpp v50, v24 quad_perm:[0,0,0,0] row_mask:0xf bank_mask:0xf
  v_mov_b32_dpp v51, v28 quad_perm:[0,0,0,0] row_mask:0xf bank_mask:0xf
  v_add_f32_dpp v48, v17, v48 quad_perm:[1,1,1,1] row_mask:0xf bank_mask:0xf
  v_add_f32_dpp v49, v21, v49 quad_perm:[1,1,1,1] row_mask:0xf bank_mask:0xf
  v_add_f32_dpp v50, v25, v50 quad_perm:[1,1,1,1] row_mask:0xf bank_mask:0xf
  v_add_f32_dpp v51, v29, v51 quad_perm:[1,1,1,1] row_mask:0xf bank_mask:0xf
  s_waitcnt vmcnt(7)
  buffer_load_dwordx4 v[152:155], v1, s[44:47], s11 offen offset:2048 nt
  v_add_f32_dpp v48, v18, v48 quad_perm:[2,2,2,2] row_mask:0xf bank_mask:0xf
  v_add_f32_dpp v49, v22, v49 quad_perm:[2,2,2,2] row_mask:0xf bank_mask:0xf
  v_add_f32_dpp v50, v26, v50 quad_perm:[2,2,2,2] row_mask:0xf bank_mask:0xf
  v_add_f32_dpp v51, v30, v51 quad_perm:[2,2,2,2] row_mask:0xf bank_mask:0xf
  v_add_f32_dpp v48, v19, v48 quad_perm:[3,3,3,3] row_mask:0xf bank_mask:0xf
  v_add_f32_dpp v49, v23, v49 quad_perm:[3,3,3,3] row_mask:0xf bank_mask:0xf
  v_add_f32_dpp v50, v27, v50 quad_perm:[3,3,3,3] row_mask:0xf bank_mask:0xf
  v_add_f32_dpp v51, v31, v51 quad_perm:[3,3,3,3] row_mask:0xf bank_mask:0xf
  s_waitcnt vmcnt(7)
  buffer_load_dwordx4 v[156:159], v1, s[44:47], s11 offen offset:3072 nt
  v_cndmask_b32 v48, v48, v49, s[60:61]
  v_cndmask_b32 v50, v50, v51, s[62:63]
  v_cndmask_b32 v48, v48, v50, s[64:65]
  v_cvt_pk_bf16_f32 v48, v48, v48
  v_lshlrev_b32 v48, 16, v48
  v_mul_f32 v48, s12, v48
  v_cvt_pk_bf16_f32 v39, v48, v48
  v_lshlrev_b32 v39, 16, v39
  s_add_u32 s10, s10, s84
  s_cmp_eq_u32 s83, 1
  s_cbranch_scc1 L_h_1
  s_waitcnt vmcnt(4)
  buffer_load_dwordx4 v[160:163], v1, s[44:47], s10 offen offset:0 nt
L_h_1:
  v_mfma_f32_16x16x32_bf16 v[16:19], v[8:11], v[96:99], 0
  v_mfma_f32_16x16x32_bf16 v[20:23], v[8:11], v[104:107], 0
  v_mfma_f32_16x16x32_bf16 v[24:27], v[8:11], v[112:115], 0
  v_mfma_f32_16x16x32_bf16 v[28:31], v[8:11], v[120:123], 0
  s_cmp_eq_u32 s83, 1
  s_cbranch_scc1 L_h_2
  s_waitcnt vmcnt(4)
  buffer_load_dwordx4 v[164:167], v1, s[44:47], s10 offen offset:1024 nt
L_h_2:
  v_mfma_f32_16x16x32_bf16 v[16:19], v[12:15], v[100:103], v[16:19]
  v_mfma_f32_16x16x32_bf16 v[20:23], v[12:15], v[108:111], v[20:23]
  v_mfma_f32_16x16x32_bf16 v[24:27], v[12:15], v[116:119], v[24:27]
  v_mfma_f32_16x16x32_bf16 v[28:31], v[12:15], v[124:127], v[28:31]
  s_cmp_eq_u32 s83, 1
  s_cbranch_scc1 L_h_3
  s_waitcnt vmcnt(4)
  buffer_load_dwordx4 v[168:171], v1, s[44:47], s10 offen offset:2048 nt
L_h_3:
  s_nop 0
  v_mov_b32_dpp v48, v16 quad_perm:[0,0,0,0] row_mask:0xf bank_mask:0xf
  v_mov_b32_dpp v49, v20 quad_perm:[0,0,0,0] row_mask:0xf bank_mask:0xf
  v_mov_b32_dpp v50, v24 quad_perm:[0,0,0,0] row_mask:0xf bank_mask:0xf
  v_mov_b32_dpp v51, v28 quad_perm:[0,0,0,0] row_mask:0xf bank_mask:0xf
  s_cmp_eq_u32 s83, 1
  s_cbranch_scc1 L_h_4
  s_waitcnt vmcnt(4)
  buffer_load_dwordx4 v[172:175], v1, s[44:47], s10 offen offset:3072 nt
L_h_4:
  v_add_f32_dpp v48, v17, v48 quad_perm:[1,1,1,1] row_mask:0xf bank_mask:0xf
  v_add_f32_dpp v49, v21, v49 quad_perm:[1,1,1,1] row_mask:0xf bank_mask:0xf
  v_add_f32_dpp v50, v25, v50 quad_perm:[1,1,1,1] row_mask:0xf bank_mask:0xf
  v_add_f32_dpp v51, v29, v51 quad_perm:[1,1,1,1] row_mask:0xf bank_mask:0xf
  s_add_u32 s11, s10, 16384
  s_cmp_eq_u32 s83, 1
  s_cbranch_scc1 L_h_5
  s_waitcnt vmcnt(4)
  buffer_load_dwordx4 v[176:179], v1, s[44:47], s11 offen offset:0 nt
L_h_5:
  v_add_f32_dpp v48, v18, v48 quad_perm:[2,2,2,2] row_mask:0xf bank_mask:0xf
  v_add_f32_dpp v49, v22, v49 quad_perm:[2,2,2,2] row_mask:0xf bank_mask:0xf
  v_add_f32_dpp v50, v26, v50 quad_perm:[2,2,2,2] row_mask:0xf bank_mask:0xf
  v_add_f32_dpp v51, v30, v51 quad_perm:[2,2,2,2] row_mask:0xf bank_mask:0xf
  s_cmp_eq_u32 s83, 1
  s_cbranch_scc1 L_h_6
  s_waitcnt vmcnt(4)
  buffer_load_dwordx4 v[180:183], v1, s[44:47], s11 offen offset:1024 nt
L_h_6:
  v_add_f32_dpp v48, v19, v48 quad_perm:[3,3,3,3] row_mask:0xf bank_mask:0xf
  v_add_f32_dpp v49, v23, v49 quad_perm:[3,3,3,3] row_mask:0xf bank_mask:0xf
  v_add_f32_dpp v50, v27, v50 quad_perm:[3,3,3,3] row_mask:0xf bank_mask:0xf
  v_add_f32_dpp v51, v31, v51 quad_perm:[3,3,3,3] row_mask:0xf bank_mask:0xf
  s_cmp_eq_u32 s83, 1
  s_cbranch_scc1 L_h_7
  s_waitcnt vmcnt(4)
  buffer_load_dwordx4 v[184:187], v1, s[44:47], s11 offen offset:2048 nt
L_h_7:
  v_cndmask_b32 v48, v48, v49, s[60:61]
  v_cndmask_b32 v50, v50, v51, s[62:63]
  v_cndmask_b32 v48, v48, v50, s[64:65]
  v_cvt_pk_bf16_f32 v48, v48, v48
  s_cmp_eq_u32 s83, 1
  s_cbranch_scc1 L_h_8
  s_waitcnt vmcnt(4)
  buffer_load_dwordx4 v[188:191], v1, s[44:47], s11 offen offset:3072 nt
L_h_8:
  v_lshlrev_b32 v48, 16, v48
  v_mul_f32 v48, s12, v48
  v_cvt_pk_bf16_f32 v40, v48, v48
  v_lshlrev_b32 v40, 16, v40
  s_cmp_eq_u32 s83, 1
  s_cselect_b32 s11, 0, s84
  s_add_u32 s10, s10, s11
  s_waitcnt vmcnt(4)
  buffer_load_dwordx4 v[192:195], v1, s[44:47], s10 offen offset:0 nt
  s_waitcnt vmcnt(4)
  buffer_load_dwordx4 v[196:199], v1, s[44:47], s10 offen offset:1024 nt
  s_waitcnt vmcnt(4)
  buffer_load_dwordx4 v[200:203], v1, s[44:47], s10 offen offset:2048 nt
  s_waitcnt vmcnt(4)
  buffer_load_dwordx4 v[204:207], v1, s[44:47], s10 offen offset:3072 nt
  s_add_u32 s11, s10, 16384
  s_waitcnt vmcnt(4)
  buffer_load_dwordx4 v[208:211], v1, s[44:47], s11 offen offset:0 nt
  v_mfma_f32_16x16x32_bf16 v[16:19], v[8:11], v[128:131], 0
  v_mfma_f32_16x16x32_bf16 v[20:23], v[8:11], v[136:139], 0
  v_mfma_f32_16x16x32_bf16 v[24:27], v[8:11], v[144:147], 0
  v_mfma_f32_16x16x32_bf16 v[28:31], v[8:11], v[152:155], 0
  v_mfma_f32_16x16x32_bf16 v[16:19], v[12:15], v[132:135], v[16:19]
  v_mfma_f32_16x16x32_bf16 v[20:23], v[12:15], v[140:143], v[20:23]
  v_mfma_f32_16x16x32_bf16 v[24:27], v[12:15], v[148:151], v[24:27]
  v_mfma_f32_16x16x32_bf16 v[28:31], v[12:15], v[156:159], v[28:31]
  s_waitcnt vmcnt(4)
  buffer_load_dwordx4 v[212:215], v1, s[44:47], s11 offen offset:1024 nt
  s_nop 2
  v_mov_b32_dpp v48, v16 quad_perm:[0,0,0,0] row_mask:0xf bank_mask:0xf
  v_mov_b32_dpp v49, v20 quad_perm:[0,0,0,0] row_mask:0xf bank_mask:0xf
  v_mov_b32_dpp v50, v24 quad_perm:[0,0,0,0] row_mask:0xf bank_mask:0xf
  v_mov_b32_dpp v51, v28 quad_perm:[0,0,0,0] row_mask:0xf bank_mask:0xf
  v_add_f32_dpp v48, v17, v48 quad_perm:[1,1,1,1] row_mask:0xf bank_mask:0xf
  v_add_f32_dpp v49, v21, v49 quad_perm:[1,1,1,1] row_mask:0xf bank_mask:0xf
  v_add_f32_dpp v50, v25, v50 quad_perm:[1,1,1,1] row_mask:0xf bank_mask:0xf
  v_add_f32_dpp v51, v29, v51 quad_perm:[1,1,1,1] row_mask:0xf bank_mask:0xf
  s_waitcnt vmcnt(4)
  buffer_load_dwordx4 v[216:219], v1, s[44:47], s11 offen offset:2048 nt
  v_add_f32_dpp v48, v18, v48 quad_perm:[2,2,2,2] row_mask:0xf bank_mask:0xf
  v_add_f32_dpp v49, v22, v49 quad_perm:[2,2,2,2] row_mask:0xf bank_mask:0xf
  v_add_f32_dpp v50, v26, v50 quad_perm:[2,2,2,2] row_mask:0xf bank_mask:0xf
  v_add_f32_dpp v51, v30, v51 quad_perm:[2,2,2,2] row_mask:0xf bank_mask:0xf
  v_add_f32_dpp v48, v19, v48 quad_perm:[3,3,3,3] row_mask:0xf bank_mask:0xf
  v_add_f32_dpp v49, v23, v49 quad_perm:[3,3,3,3] row_mask:0xf bank_mask:0xf
  v_add_f32_dpp v50, v27, v50 quad_perm:[3,3,3,3] row_mask:0xf bank_mask:0xf
  v_add_f32_dpp v51, v31, v51 quad_perm:[3,3,3,3] row_mask:0xf bank_mask:0xf
  s_waitcnt vmcnt(4)
  buffer_load_dwordx4 v[220:223], v1, s[44:47], s11 offen offset:3072 nt
  v_cndmask_b32 v48, v48, v49, s[60:61]
  v_cndmask_b32 v50, v50, v51, s[62:63]
  v_cndmask_b32 v48, v48, v50, s[64:65]
  v_cvt_pk_bf16_f32 v48, v48, v48
  v_lshlrev_b32 v48, 16, v48
  v_mul_f32 v48, s12, v48
  v_cvt_pk_bf16_f32 v41, v48, v48
  v_lshlrev_b32 v41, 16, v41
  s_add_u32 s10, s10, s84
  s_waitcnt vmcnt(4)
  buffer_load_dwordx4 v[224:227], v1, s[44:47], s10 offen offset:0 nt
  v_mfma_f32_16x16x32_bf16 v[16:19], v[8:11], v[160:163], 0
  v_mfma_f32_16x16x32_bf16 v[20:23], v[8:11], v[168:171], 0
  v_mfma_f32_16x16x32_bf16 v[24:27], v[8:11], v[176:179], 0
  v_mfma_f32_16x16x32_bf16 v[28:31], v[8:11], v[184:187], 0
  s_waitcnt vmcnt(4)
  buffer_load_dwordx4 v[228:231], v1, s[44:47], s10 offen offset:1024 nt
  v_mfma_f32_16x16x32_bf16 v[16:19], v[12:15], v[164:167], v[16:19]
  v_mfma_f32_16x16x32_bf16 v[20:23], v[12:15], v[172:175], v[20:23]
  v_mfma_f32_16x16x32_bf16 v[24:27], v[12:15], v[180:183], v[24:27]
  v_mfma_f32_16x16x32_bf16 v[28:31], v[12:15], v[188:191], v[28:31]
  s_waitcnt vmcnt(4)
  buffer_load_dwordx4 v[232:235], v1, s[44:47], s10 offen offset:2048 nt
  s_nop 2
  v_mov_b32_dpp v48, v16 quad_perm:[0,0,0,0] row_mask:0xf bank_mask:0xf
  v_mov_b32_dpp v49, v20 quad_perm:[0,0,0,0] row_mask:0xf bank_mask:0xf
  v_mov_b32_dpp v50, v24 quad_perm:[0,0,0,0] row_mask:0xf bank_mask:0xf
  v_mov_b32_dpp v51, v28 quad_perm:[0,0,0,0] row_mask:0xf bank_mask:0xf
  s_waitcnt vmcnt(4)
  buffer_load_dwordx4 v[236:239], v1, s[44:47], s10 offen offset:3072 nt
  v_add_f32_dpp v48, v17, v48 quad_perm:[1,1,1,1] row_mask:0xf bank_mask:0xf
  v_add_f32_dpp v49, v21, v49 quad_perm:[1,1,1,1] row_mask:0xf bank_mask:0xf
  v_add_f32_dpp v50, v25, v50 quad_perm:[1,1,1,1] row_mask:0xf bank_mask:0xf
  v_add_f32_dpp v51, v29, v51 quad_perm:[1,1,1,1] row_mask:0xf bank_mask:0xf
  s_add_u32 s11, s10, 16384
  s_waitcnt vmcnt(4)
  buffer_load_dwordx4 v[240:243], v1, s[44:47], s11 offen offset:0 nt
  v_add_f32_dpp v48, v18, v48 quad_perm:[2,2,2,2] row_mask:0xf bank_mask:0xf
  v_add_f32_dpp v49, v22, v49 quad_perm:[2,2,2,2] row_mask:0xf bank_mask:0xf
  v_add_f32_dpp v50, v26, v50 quad_perm:[2,2,2,2] row_mask:0xf bank_mask:0xf
  v_add_f32_dpp v51, v30, v51 quad_perm:[2,2,2,2] row_mask:0xf bank_mask:0xf
  s_waitcnt vmcnt(4)
  buffer_load_dwordx4 v[244:247], v1, s[44:47], s11 offen offset:1024 nt
  v_add_f32_dpp v48, v19, v48 quad_perm:[3,3,3,3] row_mask:0xf bank_mask:0xf
  v_add_f32_dpp v49, v23, v49 quad_perm:[3,3,3,3] row_mask:0xf bank_mask:0xf
  v_add_f32_dpp v50, v27, v50 quad_perm:[3,3,3,3] row_mask:0xf bank_mask:0xf
  v_add_f32_dpp v51, v31, v51 quad_perm:[3,3,3,3] row_mask:0xf bank_mask:0xf
  s_waitcnt vmcnt(4)
  buffer_load_dwordx4 v[248:251], v1, s[44:47], s11 offen offset:2048 nt
  v_cndmask_b32 v48, v48, v49, s[60:61]
  v_cndmask_b32 v50, v50, v51, s[62:63]
  v_cndmask_b32 v48, v48, v50, s[64:65]
  v_cvt_pk_bf16_f32 v48, v48, v48
  s_waitcnt vmcnt(4)
  buffer_load_dwordx4 v[252:255], v1, s[44:47], s11 offen offset:3072 nt
  v_lshlrev_b32 v48, 16, v48
  v_mul_f32 v48, s12, v48
  v_cvt_pk_bf16_f32 v42, v48, v48
  v_lshlrev_b32 v42, 16, v42
  s_cmp_eq_u32 s83, 1
  s_cbranch_scc0 L_own_9
  v_mov_b32 v42, 0xff7fffff
L_own_9:
  s_add_u32 s10, s10, s84
  s_waitcnt vmcnt(4)
  buffer_load_dwordx4 v[64:67], v1, s[44:47], s10 offen offset:0 nt
  v_mfma_f32_16x16x32_bf16 v[16:19], v[8:11], v[192:195], 0
  v_mfma_f32_16x16x32_bf16 v[20:23], v[8:11], v[200:203], 0
  v_mfma_f32_16x16x32_bf16 v[24:27], v[8:11], v[208:211], 0
  v_mfma_f32_16x16x32_bf16 v[28:31], v[8:11], v[216:219], 0
  s_waitcnt vmcnt(4)
  buffer_load_dwordx4 v[68:71], v1, s[44:47], s10 offen offset:1024 nt
  v_mfma_f32_16x16x32_bf16 v[16:19], v[12:15], v[196:199], v[16:19]
  v_mfma_f32_16x16x32_bf16 v[20:23], v[12:15], v[204:207], v[20:23]
  v_mfma_f32_16x16x32_bf16 v[24:27], v[12:15], v[212:215], v[24:27]
  v_mfma_f32_16x16x32_bf16 v[28:31], v[12:15], v[220:223], v[28:31]
  s_waitcnt vmcnt(4)
  buffer_load_dwordx4 v[72:75], v1, s[44:47], s10 offen offset:2048 nt
  s_nop 2
  v_mov_b32_dpp v48, v16 quad_perm:[0,0,0,0] row_mask:0xf bank_mask:0xf
  v_mov_b32_dpp v49, v20 quad_perm:[0,0,0,0] row_mask:0xf bank_mask:0xf
  v_mov_b32_dpp v50, v24 quad_perm:[0,0,0,0] row_mask:0xf bank_mask:0xf
  v_mov_b32_dpp v51, v28 quad_perm:[0,0,0,0] row_mask:0xf bank_mask:0xf
  s_waitcnt vmcnt(4)
  buffer_load_dwordx4 v[76:79], v1, s[44:47], s10 offen offset:3072 nt
  v_add_f32_dpp v48, v17, v48 quad_perm:[1,1,1,1] row_mask:0xf bank_mask:0xf
  v_add_f32_dpp v49, v21, v49 quad_perm:[1,1,1,1] row_mask:0xf bank_mask:0xf
  v_add_f32_dpp v50, v25, v50 quad_perm:[1,1,1,1] row_mask:0xf bank_mask:0xf
  v_add_f32_dpp v51, v29, v51 quad_perm:[1,1,1,1] row_mask:0xf bank_mask:0xf
  s_add_u32 s11, s10, 16384
  s_waitcnt vmcnt(4)
  buffer_load_dwordx4 v[80:83], v1, s[44:47], s11 offen offset:0 nt
  v_add_f32_dpp v48, v18, v48 quad_perm:[2,2,2,2] row_mask:0xf bank_mask:0xf
  v_add_f32_dpp v49, v22, v49 quad_perm:[2,2,2,2] row_mask:0xf bank_mask:0xf
  v_add_f32_dpp v50, v26, v50 quad_perm:[2,2,2,2] row_mask:0xf bank_mask:0xf
  v_add_f32_dpp v51, v30, v51 quad_perm:[2,2,2,2] row_mask:0xf bank_mask:0xf
  s_waitcnt vmcnt(4)
  buffer_load_dwordx4 v[84:87], v1, s[44:47], s11 offen offset:1024 nt
  v_add_f32_dpp v48, v19, v48 quad_perm:[3,3,3,3] row_mask:0xf bank_mask:0xf
  v_add_f32_dpp v49, v23, v49 quad_perm:[3,3,3,3] row_mask:0xf bank_mask:0xf
  v_add_f32_dpp v50, v27, v50 quad_perm:[3,3,3,3] row_mask:0xf bank_mask:0xf
  v_add_f32_dpp v51, v31, v51 quad_perm:[3,3,3,3] row_mask:0xf bank_mask:0xf
  s_waitcnt vmcnt(4)
  buffer_load_dwordx4 v[88:91], v1, s[44:47], s11 offen offset:2048 nt
  v_cndmask_b32 v48, v48, v49, s[60:61]
  v_cndmask_b32 v50, v50, v51, s[62:63]
  v_cndmask_b32 v48, v48, v50, s[64:65]
  v_cvt_pk_bf16_f32 v48, v48, v48
  s_waitcnt vmcnt(4)
  buffer_load_dwordx4 v[92:95], v1, s[44:47], s11 offen offset:3072 nt
  v_lshlrev_b32 v48, 16, v48
  v_mul_f32 v48, s12, v48
  v_cvt_pk_bf16_f32 v43, v48, v48
  v_lshlrev_b32 v43, 16, v43
  s_add_u32 s10, s10, s84
  s_waitcnt vmcnt(4)
  buffer_load_dwordx4 v[96:99], v1, s[44:47], s10 offen offset:0 nt
  v_mfma_f32_16x16x32_bf16 v[16:19], v[8:11], v[224:227], 0
  v_mfma_f32_16x16x32_bf16 v[20:23], v[8:11], v[232:235], 0
  v_mfma_f32_16x16x32_bf16 v[24:27], v[8:11], v[240:243], 0
  v_mfma_f32_16x16x32_bf16 v[28:31], v[8:11], v[248:251], 0
  s_waitcnt vmcnt(4)
  buffer_load_dwordx4 v[100:103], v1, s[44:47], s10 offen offset:1024 nt
  v_mfma_f32_16x16x32_bf16 v[16:19], v[12:15], v[228:231], v[16:19]
  v_mfma_f32_16x16x32_bf16 v[20:23], v[12:15], v[236:239], v[20:23]
  v_mfma_f32_16x16x32_bf16 v[24:27], v[12:15], v[244:247], v[24:27]
  v_mfma_f32_16x16x32_bf16 v[28:31], v[12:15], v[252:255], v[28:31]
  s_waitcnt vmcnt(4)
  buffer_load_dwordx4 v[104:107], v1, s[44:47], s10 offen offset:2048 nt
  s_nop 2
  v_mov_b32_dpp v48, v16 quad_perm:[0,0,0,0] row_mask:0xf bank_mask:0xf
  v_mov_b32_dpp v49, v20 quad_perm:[0,0,0,0] row_mask:0xf bank_mask:0xf
  v_mov_b32_dpp v50, v24 quad_perm:[0,0,0,0] row_mask:0xf bank_mask:0xf
  v_mov_b32_dpp v51, v28 quad_perm:[0,0,0,0] row_mask:0xf bank_mask:0xf
  s_waitcnt vmcnt(4)
  buffer_load_dwordx4 v[108:111], v1, s[44:47], s10 offen offset:3072 nt
  v_add_f32_dpp v48, v17, v48 quad_perm:[1,1,1,1] row_mask:0xf bank_mask:0xf
  v_add_f32_dpp v49, v21, v49 quad_perm:[1,1,1,1] row_mask:0xf bank_mask:0xf
  v_add_f32_dpp v50, v25, v50 quad_perm:[1,1,1,1] row_mask:0xf bank_mask:0xf
  v_add_f32_dpp v51, v29, v51 quad_perm:[1,1,1,1] row_mask:0xf bank_mask:0xf
  s_add_u32 s11, s10, 16384
  s_waitcnt vmcnt(4)
  buffer_load_dwordx4 v[112:115], v1, s[44:47], s11 offen offset:0 nt
  v_add_f32_dpp v48, v18, v48 quad_perm:[2,2,2,2] row_mask:0xf bank_mask:0xf
  v_add_f32_dpp v49, v22, v49 quad_perm:[2,2,2,2] row_mask:0xf bank_mask:0xf
  v_add_f32_dpp v50, v26, v50 quad_perm:[2,2,2,2] row_mask:0xf bank_mask:0xf
  v_add_f32_dpp v51, v30, v51 quad_perm:[2,2,2,2] row_mask:0xf bank_mask:0xf
  s_waitcnt vmcnt(4)
  buffer_load_dwordx4 v[116:119], v1, s[44:47], s11 offen offset:1024 nt
  v_add_f32_dpp v48, v19, v48 quad_perm:[3,3,3,3] row_mask:0xf bank_mask:0xf
  v_add_f32_dpp v49, v23, v49 quad_perm:[3,3,3,3] row_mask:0xf bank_mask:0xf
  v_add_f32_dpp v50, v27, v50 quad_perm:[3,3,3,3] row_mask:0xf bank_mask:0xf
  v_add_f32_dpp v51, v31, v51 quad_perm:[3,3,3,3] row_mask:0xf bank_mask:0xf
  s_waitcnt vmcnt(4)
  buffer_load_dwordx4 v[120:123], v1, s[44:47], s11 offen offset:2048 nt
  v_cndmask_b32 v48, v48, v49, s[60:61]
  v_cndmask_b32 v50, v50, v51, s[62:63]
  v_cndmask_b32 v48, v48, v50, s[64:65]
  v_cvt_pk_bf16_f32 v48, v48, v48
  s_waitcnt vmcnt(4)
  buffer_load_dwordx4 v[124:127], v1, s[44:47], s11 offen offset:3072 nt
  v_lshlrev_b32 v48, 16, v48
  v_mul_f32 v48, s12, v48
  v_cvt_pk_bf16_f32 v44, v48, v48
  v_lshlrev_b32 v44, 16, v44
  s_add_u32 s10, s10, s84
  s_waitcnt vmcnt(4)
  buffer_load_dwordx4 v[128:131], v1, s[44:47], s10 offen offset:0 nt
  v_mfma_f32_16x16x32_bf16 v[16:19], v[8:11], v[64:67], 0
  v_mfma_f32_16x16x32_bf16 v[20:23], v[8:11], v[72:75], 0
  v_mfma_f32_16x16x32_bf16 v[24:27], v[8:11], v[80:83], 0
  v_mfma_f32_16x16x32_bf16 v[28:31], v[8:11], v[88:91], 0
  s_waitcnt vmcnt(4)
  buffer_load_dwordx4 v[132:135], v1, s[44:47], s10 offen offset:1024 nt
  v_mfma_f32_16x16x32_bf16 v[16:19], v[12:15], v[68:71], v[16:19]
  v_mfma_f32_16x16x32_bf16 v[20:23], v[12:15], v[76:79], v[20:23]
  v_mfma_f32_16x16x32_bf16 v[24:27], v[12:15], v[84:87], v[24:27]
  v_mfma_f32_16x16x32_bf16 v[28:31], v[12:15], v[92:95], v[28:31]
  s_waitcnt vmcnt(4)
  buffer_load_dwordx4 v[136:139], v1, s[44:47], s10 offen offset:2048 nt
  s_nop 2
  v_mov_b32_dpp v48, v16 quad_perm:[0,0,0,0] row_mask:0xf bank_mask:0xf
  v_mov_b32_dpp v49, v20 quad_perm:[0,0,0,0] row_mask:0xf bank_mask:0xf
  v_mov_b32_dpp v50, v24 quad_perm:[0,0,0,0] row_mask:0xf bank_mask:0xf
  v_mov_b32_dpp v51, v28 quad_perm:[0,0,0,0] row_mask:0xf bank_mask:0xf
  s_waitcnt vmcnt(4)
  buffer_load_dwordx4 v[140:143], v1, s[44:47], s10 offen offset:3072 nt
  v_add_f32_dpp v48, v17, v48 quad_perm:[1,1,1,1] row_mask:0xf bank_mask:0xf
  v_add_f32_dpp v49, v21, v49 quad_perm:[1,1,1,1] row_mask:0xf bank_mask:0xf
  v_add_f32_dpp v50, v25, v50 quad_perm:[1,1,1,1] row_mask:0xf bank_mask:0xf
  v_add_f32_dpp v51, v29, v51 quad_perm:[1,1,1,1] row_mask:0xf bank_mask:0xf
  s_add_u32 s11, s10, 16384
  s_waitcnt vmcnt(4)
  buffer_load_dwordx4 v[144:147], v1, s[44:47], s11 offen offset:0 nt
  v_add_f32_dpp v48, v18, v48 quad_perm:[2,2,2,2] row_mask:0xf bank_mask:0xf
  v_add_f32_dpp v49, v22, v49 quad_perm:[2,2,2,2] row_mask:0xf bank_mask:0xf
  v_add_f32_dpp v50, v26, v50 quad_perm:[2,2,2,2] row_mask:0xf bank_mask:0xf
  v_add_f32_dpp v51, v30, v51 quad_perm:[2,2,2,2] row_mask:0xf bank_mask:0xf
  s_waitcnt vmcnt(4)
  buffer_load_dwordx4 v[148:151], v1, s[44:47], s11 offen offset:1024 nt
  v_add_f32_dpp v48, v19, v48 quad_perm:[3,3,3,3] row_mask:0xf bank_mask:0xf
  v_add_f32_dpp v49, v23, v49 quad_perm:[3,3,3,3] row_mask:0xf bank_mask:0xf
  v_add_f32_dpp v50, v27, v50 quad_perm:[3,3,3,3] row_mask:0xf bank_mask:0xf
  v_add_f32_dpp v51, v31, v51 quad_perm:[3,3,3,3] row_mask:0xf bank_mask:0xf
  s_waitcnt vmcnt(4)
  buffer_load_dwordx4 v[152:155], v1, s[44:47], s11 offen offset:2048 nt
  v_cndmask_b32 v48, v48, v49, s[60:61]
  v_cndmask_b32 v50, v50, v51, s[62:63]
  v_cndmask_b32 v48, v48, v50, s[64:65]
  v_cvt_pk_bf16_f32 v48, v48, v48
  s_waitcnt vmcnt(4)
  buffer_load_dwordx4 v[156:159], v1, s[44:47], s11 offen offset:3072 nt
  v_lshlrev_b32 v48, 16, v48
  v_mul_f32 v48, s12, v48
  v_cvt_pk_bf16_f32 v45, v48, v48
  v_lshlrev_b32 v45, 16, v45
  s_add_u32 s10, s10, s84
  s_bitcmp0_b32 s78, 0
  s_cbranch_scc1 L_h_10
  s_waitcnt vmcnt(4)
  buffer_load_dwordx4 v[160:163], v1, s[44:47], s10 offen offset:0 nt
L_h_10:
  v_mfma_f32_16x16x32_bf16 v[16:19], v[8:11], v[96:99], 0
  v_mfma_f32_16x16x32_bf16 v[20:23], v[8:11], v[104:107], 0
  v_mfma_f32_16x16x32_bf16 v[24:27], v[8:11], v[112:115], 0
  v_mfma_f32_16x16x32_bf16 v[28:31], v[8:11], v[120:123], 0
  s_bitcmp0_b32 s78, 1
  s_cbranch_scc1 L_h_11
  s_waitcnt vmcnt(4)
  buffer_load_dwordx4 v[164:167], v1, s[44:47], s10 offen offset:1024 nt
L_h_11:
  v_mfma_f32_16x16x32_bf16 v[16:19], v[12:15], v[100:103], v[16:19]
  v_mfma_f32_16x16x32_bf16 v[20:23], v[12:15], v[108:111], v[20:23]
  v_mfma_f32_16x16x32_bf16 v[24:27], v[12:15], v[116:119], v[24:27]
  v_mfma_f32_16x16x32_bf16 v[28:31], v[12:15], v[124:127], v[28:31]
  s_bitcmp0_b32 s78, 2
  s_cbranch_scc1 L_h_12
  s_waitcnt vmcnt(4)
  buffer_load_dwordx4 v[168:171], v1, s[44:47], s10 offen offset:2048 nt
L_h_12:
  s_nop 0
  v_mov_b32_dpp v48, v16 quad_perm:[0,0,0,0] row_mask:0xf bank_mask:0xf
  v_mov_b32_dpp v49, v20 quad_perm:[0,0,0,0] row_mask:0xf bank_mask:0xf
  v_mov_b32_dpp v50, v24 quad_perm:[0,0,0,0] row_mask:0xf bank_mask:0xf
  v_mov_b32_dpp v51, v28 quad_perm:[0,0,0,0] row_mask:0xf bank_mask:0xf
  s_bitcmp0_b32 s78, 3
  s_cbranch_scc1 L_h_13
  s_waitcnt vmcnt(4)
  buffer_load_dwordx4 v[172:175], v1, s[44:47], s10 offen offset:3072 nt
L_h_13:
  v_add_f32_dpp v48, v17, v48 quad_perm:[1,1,1,1] row_mask:0xf bank_mask:0xf
  v_add_f32_dpp v49, v21, v49 quad_perm:[1,1,1,1] row_mask:0xf bank_mask:0xf
  v_add_f32_dpp v50, v25, v50 quad_perm:[1,1,1,1] row_mask:0xf bank_mask:0xf
  v_add_f32_dpp v51, v29, v51 quad_perm:[1,1,1,1] row_mask:0xf bank_mask:0xf
  s_add_u32 s11, s10, 16384
  s_bitcmp0_b32 s78, 4
  s_cbranch_scc1 L_h_14
  s_waitcnt vmcnt(4)
  buffer_load_dwordx4 v[176:179], v1, s[44:47], s11 offen offset:0 nt
L_h_14:
  v_add_f32_dpp v48, v18, v48 quad_perm:[2,2,2,2] row_mask:0xf bank_mask:0xf
  v_add_f32_dpp v49, v22, v49 quad_perm:[2,2,2,2] row_mask:0xf bank_mask:0xf
  v_add_f32_dpp v50, v26, v50 quad_perm:[2,2,2,2] row_mask:0xf bank_mask:0xf
  v_add_f32_dpp v51, v30, v51 quad_perm:[2,2,2,2] row_mask:0xf bank_mask:0xf
  s_bitcmp0_b32 s78, 5
  s_cbranch_scc1 L_h_15
  s_waitcnt vmcnt(4)
  buffer_load_dwordx4 v[180:183], v1, s[44:47], s11 offen offset:1024 nt
L_h_15:
  v_add_f32_dpp v48, v19, v48 quad_perm:[3,3,3,3] row_mask:0xf bank_mask:0xf
  v_add_f32_dpp v49, v23, v49 quad_perm:[3,3,3,3] row_mask:0xf bank_mask:0xf
  v_add_f32_dpp v50, v27, v50 quad_perm:[3,3,3,3] row_mask:0xf bank_mask:0xf
  v_add_f32_dpp v51, v31, v51 quad_perm:[3,3,3,3] row_mask:0xf bank_mask:0xf
  s_bitcmp0_b32 s78, 6
  s_cbranch_scc1 L_h_16
  s_waitcnt vmcnt(4)
  buffer_load_dwordx4 v[184:187], v1, s[44:47], s11 offen offset:2048 nt
L_h_16:
  v_cndmask_b32 v48, v48, v49, s[60:61]
  v_cndmask_b32 v50, v50, v51, s[62:63]
  v_cndmask_b32 v48, v48, v50, s[64:65]
  v_cvt_pk_bf16_f32 v48, v48, v48
  s_bitcmp0_b32 s78, 7
  s_cbranch_scc1 L_h_17
  s_waitcnt vmcnt(4)
  buffer_load_dwordx4 v[188:191], v1, s[44:47], s11 offen offset:3072 nt
L_h_17:
  v_lshlrev_b32 v48, 16, v48
  v_mul_f32 v48, s12, v48
  v_cvt_pk_bf16_f32 v46, v48, v48
  v_lshlrev_b32 v46, 16, v46
  s_add_u32 s10, s10, s84
  s_mov_b32 s10, s85
  s_waitcnt vmcnt(4)
  buffer_load_dwordx4 v[192:195], v2, s[48:51], s10 offen offset:0 nt
  v_mfma_f32_16x16x32_bf16 v[16:19], v[8:11], v[128:131], 0
  v_mfma_f32_16x16x32_bf16 v[20:23], v[8:11], v[136:139], 0
  v_mfma_f32_16x16x32_bf16 v[24:27], v[8:11], v[144:147], 0
  v_mfma_f32_16x16x32_bf16 v[28:31], v[8:11], v[152:155], 0
  v_mfma_f32_16x16x32_bf16 v[16:19], v[12:15], v[132:135], v[16:19]
  v_mfma_f32_16x16x32_bf16 v[20:23], v[12:15], v[140:143], v[20:23]
  v_mfma_f32_16x16x32_bf16 v[24:27], v[12:15], v[148:151], v[24:27]
  v_mfma_f32_16x16x32_bf16 v[28:31], v[12:15], v[156:159], v[28:31]
  s_waitcnt vmcnt(4)
  buffer_load_dwordx4 v[196:199], v2, s[48:51], s10 offen offset:1024 nt
  s_nop 2
  v_mov_b32_dpp v48, v16 quad_perm:[0,0,0,0] row_mask:0xf bank_mask:0xf
  v_mov_b32_dpp v49, v20 quad_perm:[0,0,0,0] row_mask:0xf bank_mask:0xf
  v_mov_b32_dpp v50, v24 quad_perm:[0,0,0,0] row_mask:0xf bank_mask:0xf
  v_mov_b32_dpp v51, v28 quad_perm:[0,0,0,0] row_mask:0xf bank_mask:0xf
  v_add_f32_dpp v48, v17, v48 quad_perm:[1,1,1,1] row_mask:0xf bank_mask:0xf
  v_add_f32_dpp v49, v21, v49 quad_perm:[1,1,1,1] row_mask:0xf bank_mask:0xf
  v_add_f32_dpp v50, v25, v50 quad_perm:[1,1,1,1] row_mask:0xf bank_mask:0xf
  v_add_f32_dpp v51, v29, v51 quad_perm:[1,1,1,1] row_mask:0xf bank_mask:0xf
  s_waitcnt vmcnt(4)
  buffer_load_dwordx4 v[200:203], v2, s[48:51], s10 offen offset:2048 nt
  v_add_f32_dpp v48, v18, v48 quad_perm:[2,2,2,2] row_mask:0xf bank_mask:0xf
  v_add_f32_dpp v49, v22, v49 quad_perm:[2,2,2,2] row_mask:0xf bank_mask:0xf
  v_add_f32_dpp v50, v26, v50 quad_perm:[2,2,2,2] row_mask:0xf bank_mask:0xf
  v_add_f32_dpp v51, v30, v51 quad_perm:[2,2,2,2] row_mask:0xf bank_mask:0xf
  v_add_f32_dpp v48, v19, v48 quad_perm:[3,3,3,3] row_mask:0xf bank_mask:0xf
  v_add_f32_dpp v49, v23, v49 quad_perm:[3,3,3,3] row_mask:0xf bank_mask:0xf
  v_add_f32_dpp v50, v27, v50 quad_perm:[3,3,3,3] row_mask:0xf bank_mask:0xf
  v_add_f32_dpp v51, v31, v51 quad_perm:[3,3,3,3] row_mask:0xf bank_mask:0xf
  s_waitcnt vmcnt(4)
  buffer_load_dwordx4 v[204:207], v2, s[48:51], s10 offen offset:3072 nt
  v_cndmask_b32 v48, v48, v49, s[60:61]
  v_cndmask_b32 v50, v50, v51, s[62:63]
  v_cndmask_b32 v48, v48, v50, s[64:65]
  v_cvt_pk_bf16_f32 v48, v48, v48
  v_lshlrev_b32 v48, 16, v48
  v_mul_f32 v48, s12, v48
  v_cvt_pk_bf16_f32 v47, v48, v48
  v_lshlrev_b32 v47, 16, v47
  s_add_u32 s11, s10, 16384
  s_waitcnt vmcnt(4)
  buffer_load_dwordx4 v[208:211], v2, s[48:51], s11 offen offset:0 nt
  v_mfma_f32_16x16x32_bf16 v[16:19], v[8:11], v[160:163], 0
  v_mfma_f32_16x16x32_bf16 v[20:23], v[8:11], v[168:171], 0
  v_mfma_f32_16x16x32_bf16 v[24:27], v[8:11], v[176:179], 0
  v_mfma_f32_16x16x32_bf16 v[28:31], v[8:11], v[184:187], 0
  v_mfma_f32_16x16x32_bf16 v[16:19], v[12:15], v[164:167], v[16:19]
  v_mfma_f32_16x16x32_bf16 v[20:23], v[12:15], v[172:175], v[20:23]
  v_mfma_f32_16x16x32_bf16 v[24:27], v[12:15], v[180:183], v[24:27]
  v_mfma_f32_16x16x32_bf16 v[28:31], v[12:15], v[188:191], v[28:31]
  s_waitcnt vmcnt(4)
  buffer_load_dwordx4 v[212:215], v2, s[48:51], s11 offen offset:1024 nt
  s_nop 2
  v_mov_b32_dpp v48, v16 quad_perm:[0,0,0,0] row_mask:0xf bank_mask:0xf
  v_mov_b32_dpp v49, v20 quad_perm:[0,0,0,0] row_mask:0xf bank_mask:0xf
  v_mov_b32_dpp v50, v24 quad_perm:[0,0,0,0] row_mask:0xf bank_mask:0xf
  v_mov_b32_dpp v51, v28 quad_perm:[0,0,0,0] row_mask:0xf bank_mask:0xf
  v_add_f32_dpp v48, v17, v48 quad_perm:[1,1,1,1] row_mask:0xf bank_mask:0xf
  v_add_f32_dpp v49, v21, v49 quad_perm:[1,1,1,1] row_mask:0xf bank_mask:0xf
  v_add_f32_dpp v50, v25, v50 quad_perm:[1,1,1,1] row_mask:0xf bank_mask:0xf
  v_add_f32_dpp v51, v29, v51 quad_perm:[1,1,1,1] row_mask:0xf bank_mask:0xf
  v_add_f32_dpp v48, v18, v48 quad_perm:[2,2,2,2] row_mask:0xf bank_mask:0xf
  s_waitcnt vmcnt(4)
  buffer_load_dwordx4 v[216:219], v2, s[48:51], s11 offen offset:2048 nt
  v_add_f32_dpp v49, v22, v49 quad_perm:[2,2,2,2] row_mask:0xf bank_mask:0xf
  v_add_f32_dpp v50, v26, v50 quad_perm:[2,2,2,2] row_mask:0xf bank_mask:0xf
  v_add_f32_dpp v51, v30, v51 quad_perm:[2,2,2,2] row_mask:0xf bank_mask:0xf
  v_add_f32_dpp v48, v19, v48 quad_perm:[3,3,3,3] row_mask:0xf bank_mask:0xf
  v_add_f32_dpp v49, v23, v49 quad_perm:[3,3,3,3] row_mask:0xf bank_mask:0xf
  v_add_f32_dpp v50, v27, v50 quad_perm:[3,3,3,3] row_mask:0xf bank_mask:0xf
  v_add_f32_dpp v51, v31, v51 quad_perm:[3,3,3,3] row_mask:0xf bank_mask:0xf
  v_cndmask_b32 v48, v48, v49, s[60:61]
  s_waitcnt vmcnt(4)
  buffer_load_dwordx4 v[220:223], v2, s[48:51], s11 offen offset:3072 nt
  v_cndmask_b32 v50, v50, v51, s[62:63]
  v_cndmask_b32 v48, v48, v50, s[64:65]
  v_cvt_pk_bf16_f32 v48, v48, v48
  v_lshlrev_b32 v48, 16, v48
  v_mul_f32 v48, s12, v48
  v_cvt_pk_bf16_f32 v56, v48, v48
  v_lshlrev_b32 v56, 16, v56
  v_mov_b32 v57, 0xff7fffff
  v_cndmask_b32 v56, v56, v57, s[80:81]
  s_add_u32 s10, s10, s84
  s_waitcnt vmcnt(4)
  buffer_load_dwordx4 v[224:227], v2, s[48:51], s10 offen offset:0 nt
  v_max3_f32 v48, v32, v33, v34
  v_max3_f32 v48, v48, v35, v36
  v_max3_f32 v48, v48, v37, v38
  v_max3_f32 v48, v48, v39, v40
  v_max3_f32 v48, v48, v41, v42
  v_max3_f32 v48, v48, v43, v44
  v_max3_f32 v48, v48, v45, v46
  v_max3_f32 v48, v48, v47, v56
  s_nop 1
  v_max_f32_dpp v48, v48, v48 quad_perm:[1,0,3,2] row_mask:0xf bank_mask:0xf
  s_nop 1
  v_max_f32_dpp v48, v48, v48 quad_perm:[2,3,0,1] row_mask:0xf bank_mask:0xf
  s_nop 1
  v_max_f32_dpp v48, v48, v48 row_half_mirror row_mask:0xf bank_mask:0xf
  s_nop 1
  v_max_f32_dpp v48, v48, v48 row_mirror row_mask:0xf bank_mask:0xf
  v_mov_b32 v49, v48
  s_nop 1
  v_permlane16_swap_b32 v48, v49
  v_max_f32 v48, v48, v49
  s_mov_b32 s12, 1069066811
  v_sub_f32 v16, v32, v48
  v_sub_f32 v17, v33, v48
  v_sub_f32 v18, v34, v48
  v_sub_f32 v19, v35, v48
  v_sub_f32 v20, v36, v48
  v_sub_f32 v21, v37, v48
  v_sub_f32 v22, v38, v48
  v_sub_f32 v23, v39, v48
  v_sub_f32 v24, v40, v48
  s_waitcnt vmcnt(4)
  buffer_load_dwordx4 v[228:231], v2, s[48:51], s10 offen offset:1024 nt
  v_sub_f32 v25, v41, v48
  v_sub_f32 v26, v42, v48
  v_sub_f32 v27, v43, v48
  v_sub_f32 v28, v44, v48
  v_sub_f32 v29, v45, v48
  v_sub_f32 v30, v46, v48
  v_sub_f32 v31, v47, v48
  v_sub_f32 v50, v56, v48
  v_mul_f32 v16, s12, v16
  v_mul_f32 v17, s12, v17
  v_mul_f32 v18, s12, v18
  v_mul_f32 v19, s12, v19
  v_mul_f32 v20, s12, v20
  v_mul_f32 v21, s12, v21
  v_mul_f32 v22, s12, v22
  v_mul_f32 v23, s12, v23
  v_mul_f32 v24, s12, v24
  v_mul_f32 v25, s12, v25
  v_mul_f32 v26, s12, v26
  v_mul_f32 v27, s12, v27
  v_mul_f32 v28, s12, v28
  v_mul_f32 v29, s12, v29
  v_mul_f32 v30, s12, v30
  v_mul_f32 v31, s12, v31
  v_mul_f32 v50, s12, v50
  s_waitcnt vmcnt(4)
  buffer_load_dwordx4 v[232:235], v2, s[48:51], s10 offen offset:2048 nt
  v_exp_f32 v16, v16
  v_exp_f32 v17, v17
  v_exp_f32 v18, v18
  v_exp_f32 v19, v19
  v_exp_f32 v20, v20
  v_exp_f32 v21, v21
  v_exp_f32 v22, v22
  v_exp_f32 v23, v23
  v_exp_f32 v24, v24
  v_exp_f32 v25, v25
  v_exp_f32 v26, v26
  v_exp_f32 v27, v27
  v_exp_f32 v28, v28
  v_exp_f32 v29, v29
  v_exp_f32 v30, v30
  v_exp_f32 v31, v31
  v_exp_f32 v50, v50
  v_add_f32 v16, v16, v24
  v_add_f32 v17, v17, v25
  v_add_f32 v18, v18, v26
  v_add_f32 v19, v19, v27
  v_add_f32 v20, v20, v28
  v_add_f32 v21, v21, v29
  v_add_f32 v22, v22, v30
  v_add_f32 v23, v23, v31
  s_waitcnt vmcnt(4)
  buffer_load_dwordx4 v[236:239], v2, s[48:51], s10 offen offset:3072 nt
  v_add_f32 v16, v16, v20
  v_add_f32 v17, v17, v21
  v_add_f32 v18, v18, v22
  v_add_f32 v19, v19, v23
  v_add_f32 v16, v16, v18
  v_add_f32 v17, v17, v19
  v_add_f32 v16, v16, v17
  v_add_f32 v50, v50, v16
  s_nop 1
  v_add_f32_dpp v50, v50, v50 quad_perm:[1,0,3,2] row_mask:0xf bank_mask:0xf
  s_nop 1
  v_add_f32_dpp v50, v50, v50 quad_perm:[2,3,0,1] row_mask:0xf bank_mask:0xf
  s_nop 1
  v_add_f32_dpp v50, v50, v50 row_half_mirror row_mask:0xf bank_mask:0xf
  s_nop 1
  v_add_f32_dpp v50, v50, v50 row_mirror row_mask:0xf bank_mask:0xf
  v_mov_b32 v49, v50
  s_nop 1
  v_permlane16_swap_b32 v50, v49
  v_add_f32 v50, v50, v49
  v_mov_b32 v49, v50
  v_lshrrev_b32 v5, 5, v4
  v_lshlrev_b32 v5, 3, v5
  s_lshl_b32 s8, s3, 4
  s_add_u32 s8, s8, 160416
  v_add_u32 v6, s8, v5
  v_mov_b32 v51, 160328
  v_mov_b32 v50, 1
  s_mov_b32 exec_lo, 1
  s_mov_b32 exec_hi, 1
  ds_write_b64 v6, v[48:49]
  s_waitcnt lgkmcnt(0)
  s_mov_b32 exec_hi, 0
  ds_add_u32 v51, v50 offset:8
  s_mov_b64 exec, -1
  v_add_u32 v6, 160480, v5
  s_add_u32 s11, s10, 16384
  s_waitcnt vmcnt(4)
  buffer_load_dwordx4 v[240:243], v2, s[48:51], s11 offen offset:0 nt
  s_waitcnt vmcnt(4)
  buffer_load_dwordx4 v[244:247], v2, s[48:51], s11 offen offset:1024 nt
  s_waitcnt vmcnt(4)
  buffer_load_dwordx4 v[248:251], v2, s[48:51], s11 offen offset:2048 nt
  s_waitcnt vmcnt(4)
  buffer_load_dwordx4 v[252:255], v2, s[48:51], s11 offen offset:3072 nt
  s_add_u32 s10, s10, s84
  s_waitcnt vmcnt(4)
  buffer_load_dwordx4 v[64:67], v2, s[48:51], s10 offen offset:0 nt
  s_waitcnt vmcnt(4)
  buffer_load_dwordx4 v[68:71], v2, s[48:51], s10 offen offset:1024 nt
  s_waitcnt vmcnt(4)
  buffer_load_dwordx4 v[72:75], v2, s[48:51], s10 offen offset:2048 nt
  s_waitcnt vmcnt(4)
  buffer_load_dwordx4 v[76:79], v2, s[48:51], s10 offen offset:3072 nt
  s_add_u32 s11, s10, 16384
  s_waitcnt vmcnt(4)
  buffer_load_dwordx4 v[80:83], v2, s[48:51], s11 offen offset:0 nt
  s_waitcnt vmcnt(4)
  buffer_load_dwordx4 v[84:87], v2, s[48:51], s11 offen offset:1024 nt
  s_waitcnt vmcnt(4)
  buffer_load_dwordx4 v[88:91], v2, s[48:51], s11 offen offset:2048 nt
  s_waitcnt vmcnt(4)
  buffer_load_dwordx4 v[92:95], v2, s[48:51], s11 offen offset:3072 nt
  s_add_u32 s10, s10, s84
  s_waitcnt vmcnt(4)
  buffer_load_dwordx4 v[96:99], v2, s[48:51], s10 offen offset:0 nt
  s_waitcnt vmcnt(4)
  buffer_load_dwordx4 v[100:103], v2, s[48:51], s10 offen offset:1024 nt
  s_waitcnt vmcnt(4)
  buffer_load_dwordx4 v[104:107], v2, s[48:51], s10 offen offset:2048 nt
  s_waitcnt vmcnt(4)
  buffer_load_dwordx4 v[108:111], v2, s[48:51], s10 offen offset:3072 nt
  s_add_u32 s11, s10, 16384
  s_waitcnt vmcnt(4)
  buffer_load_dwordx4 v[112:115], v2, s[48:51], s11 offen offset:0 nt
  s_waitcnt vmcnt(4)
  buffer_load_dwordx4 v[116:119], v2, s[48:51], s11 offen offset:1024 nt
  s_waitcnt vmcnt(4)
  buffer_load_dwordx4 v[120:123], v2, s[48:51], s11 offen offset:2048 nt
  s_waitcnt vmcnt(4)
  buffer_load_dwordx4 v[124:127], v2, s[48:51], s11 offen offset:3072 nt
  s_add_u32 s10, s10, s84
  s_waitcnt vmcnt(4)
  buffer_load_dwordx4 v[128:131], v2, s[48:51], s10 offen offset:0 nt
  v_lshrrev_b32 v5, 5, v4
  s_waitcnt vmcnt(4)
  buffer_load_dwordx4 v[132:135], v2, s[48:51], s10 offen offset:1024 nt
  v_lshlrev_b32 v5, 6, v5
  v_bfe_u32 v48, v4, 2, 2
  s_waitcnt vmcnt(4)
  buffer_load_dwordx4 v[136:139], v2, s[48:51], s10 offen offset:2048 nt
  v_lshlrev_b32 v48, 4, v48
  v_add_u32 v5, v5, v48
  s_waitcnt vmcnt(4)
  buffer_load_dwordx4 v[140:143], v2, s[48:51], s10 offen offset:3072 nt
  v_and_b32 v48, 3, v4
  v_lshlrev_b32 v48, 2, v48
  s_add_u32 s11, s10, 16384
  s_waitcnt vmcnt(4)
  buffer_load_dwordx4 v[144:147], v2, s[48:51], s11 offen offset:0 nt
  v_add_u32 v5, v5, v48
  s_waitcnt vmcnt(4)
  buffer_load_dwordx4 v[148:151], v2, s[48:51], s11 offen offset:1024 nt
  v_bfe_u32 v48, v4, 4, 1
  v_lshlrev_b32 v48, 1, v48
  s_waitcnt vmcnt(4)
  buffer_load_dwordx4 v[152:155], v2, s[48:51], s11 offen offset:2048 nt
  v_add_u32 v5, v5, v48
  s_mul_i32 s15, s3, 3072
  s_waitcnt vmcnt(4)
  buffer_load_dwordx4 v[156:159], v2, s[48:51], s11 offen offset:3072 nt
  s_add_u32 s15, s15, 147456
  v_add_u32 v5, s15, v5
  s_add_u32 s10, s10, s84
  s_mov_b32 s92, 2400000
L_swait:
  ds_read_b32 v52, v51 offset:12
  ds_read_b64 v[48:49], v6
  s_waitcnt lgkmcnt(0)
  v_readfirstlane_b32 s8, v52
  s_nop 1
  s_cmp_lg_u32 s8, 0
  s_cbranch_scc1 L_sok
  s_sub_u32 s92, s92, 1
  s_cbranch_scc1 L_sok
  s_sleep 1
  s_branch L_swait
L_sok:
  s_cmp_eq_u32 s8, 2
  s_cselect_b64 vcc, -1, 0
  s_waitcnt vmcnt(5)
  s_cbranch_vccnz L_b_18
  s_waitcnt vmcnt(4)
L_b_18:
  buffer_load_dwordx4 v[160:163], v2, s[48:51], s10 offen offset:0 nt
  v_mov_b32 v51, v49
  v_sub_f32 v32, v32, v48
  v_sub_f32 v33, v33, v48
  v_sub_f32 v34, v34, v48
  v_sub_f32 v35, v35, v48
  v_sub_f32 v36, v36, v48
  v_sub_f32 v37, v37, v48
  v_sub_f32 v38, v38, v48
  v_sub_f32 v39, v39, v48
  v_sub_f32 v40, v40, v48
  v_sub_f32 v41, v41, v48
  v_sub_f32 v42, v42, v48
  v_sub_f32 v43, v43, v48
  v_sub_f32 v44, v44, v48
  v_sub_f32 v45, v45, v48
  v_sub_f32 v46, v46, v48
  v_sub_f32 v47, v47, v48
  v_sub_f32 v56, v56, v48
  v_mul_f32 v32, s12, v32
  s_waitcnt vmcnt(5)
  s_cbranch_vccnz L_b_19
  s_waitcnt vmcnt(4)
L_b_19:
  buffer_load_dwordx4 v[164:167], v2, s[48:51], s10 offen offset:1024 nt
  v_mul_f32 v33, s12, v33
  v_mul_f32 v34, s12, v34
  v_mul_f32 v35, s12, v35
  v_mul_f32 v36, s12, v36
  v_mul_f32 v37, s12, v37
  v_mul_f32 v38, s12, v38
  v_mul_f32 v39, s12, v39
  v_mul_f32 v40, s12, v40
  v_mul_f32 v41, s12, v41
  v_mul_f32 v42, s12, v42
  v_mul_f32 v43, s12, v43
  v_mul_f32 v44, s12, v44
  v_mul_f32 v45, s12, v45
  v_mul_f32 v46, s12, v46
  v_mul_f32 v47, s12, v47
  v_mul_f32 v56, s12, v56
  v_exp_f32 v32, v32
  v_exp_f32 v33, v33
  v_exp_f32 v34, v34
  v_exp_f32 v35, v35
  s_waitcnt vmcnt(5)
  s_cbranch_vccnz L_b_20
  s_waitcnt vmcnt(4)
L_b_20:
  buffer_load_dwordx4 v[168:171], v2, s[48:51], s10 offen offset:2048 nt
  v_exp_f32 v36, v36
  v_exp_f32 v37, v37
  v_exp_f32 v38, v38
  v_exp_f32 v39, v39
  v_exp_f32 v40, v40
  v_exp_f32 v41, v41
  v_exp_f32 v42, v42
  v_exp_f32 v43, v43
  v_exp_f32 v44, v44
  v_exp_f32 v45, v45
  v_exp_f32 v46, v46
  v_exp_f32 v47, v47
  v_exp_f32 v56, v56
  v_mul_f32 v32, v32, v51
  v_mul_f32 v33, v33, v51
  v_mul_f32 v34, v34, v51
  v_mul_f32 v35, v35, v51
  v_mul_f32 v36, v36, v51
  v_mul_f32 v37, v37, v51
  s_waitcnt vmcnt(5)
  s_cbranch_vccnz L_b_21
  s_waitcnt vmcnt(4)
L_b_21:
  buffer_load_dwordx4 v[172:175], v2, s[48:51], s10 offen offset:3072 nt
  v_mul_f32 v38, v38, v51
  v_mul_f32 v39, v39, v51
  v_mul_f32 v40, v40, v51
  v_mul_f32 v41, v41, v51
  v_mul_f32 v42, v42, v51
  v_mul_f32 v43, v43, v51
  v_mul_f32 v44, v44, v51
  v_mul_f32 v45, v45, v51
  v_mul_f32 v46, v46, v51
  v_mul_f32 v47, v47, v51
  v_mul_f32 v56, v56, v51
  v_cvt_pk_bf16_f32 v32, v32, v32
  ds_write_b16 v5, v32 offset:0
  v_cvt_pk_bf16_f32 v33, v33, v33
  ds_write_b16 v5, v33 offset:128
  v_cvt_pk_bf16_f32 v34, v34, v34
  ds_write_b16 v5, v34 offset:256
  v_cvt_pk_bf16_f32 v35, v35, v35
  ds_write_b16 v5, v35 offset:384
  v_cvt_pk_bf16_f32 v36, v36, v36
  s_add_u32 s11, s10, 16384
  s_waitcnt vmcnt(5)
  s_cbranch_vccnz L_b_22
  s_waitcnt vmcnt(4)
L_b_22:
  buffer_load_dwordx4 v[176:179], v2, s[48:51], s11 offen offset:0 nt
  ds_write_b16 v5, v36 offset:512
  v_cvt_pk_bf16_f32 v37, v37, v37
  ds_write_b16 v5, v37 offset:640
  v_cvt_pk_bf16_f32 v38, v38, v38
  ds_write_b16 v5, v38 offset:768
  v_cvt_pk_bf16_f32 v39, v39, v39
  ds_write_b16 v5, v39 offset:896
  v_cvt_pk_bf16_f32 v40, v40, v40
  ds_write_b16 v5, v40 offset:1024
  v_cvt_pk_bf16_f32 v41, v41, v41
  ds_write_b16 v5, v41 offset:1152
  v_cvt_pk_bf16_f32 v42, v42, v42
  ds_write_b16 v5, v42 offset:1280
  v_cvt_pk_bf16_f32 v43, v43, v43
  ds_write_b16 v5, v43 offset:1408
  v_cvt_pk_bf16_f32 v44, v44, v44
  ds_write_b16 v5, v44 offset:1536
  v_cvt_pk_bf16_f32 v45, v45, v45
  ds_write_b16 v5, v45 offset:1664
  v_cvt_pk_bf16_f32 v46, v46, v46
  s_waitcnt vmcnt(5)
  s_cbranch_vccnz L_b_23
  s_waitcnt vmcnt(4)
L_b_23:
  buffer_load_dwordx4 v[180:183], v2, s[48:51], s11 offen offset:1024 nt
  ds_write_b16 v5, v46 offset:1792
  v_cvt_pk_bf16_f32 v47, v47, v47
  ds_write_b16 v5, v47 offset:1920
  v_cvt_pk_bf16_f32 v56, v56, v56
  ds_write_b16 v5, v56 offset:2048
  v_and_b32 v6, 1, v4
  v_lshlrev_b32 v6, 6, v6
  v_lshrrev_b32 v5, 4, v4
  v_lshlrev_b32 v5, 4, v5
  v_add3_u32 v5, v5, v6, s15
  s_lshl_b32 s14, s83, 7
  s_mov_b32 s8, 0x05040100
  s_mov_b32 s9, 0x07060302
  s_mov_b32 s86, 16
  s_nop 0
  s_waitcnt lgkmcnt(0)
  ds_read_b128 v[8:11], v5
  v_perm_b32 v16, v196, v192, s8
  v_perm_b32 v17, v204, v200, s8
  s_waitcnt vmcnt(5)
  s_cbranch_vccnz L_b_24
  s_waitcnt vmcnt(4)
L_b_24:
  buffer_load_dwordx4 v[184:187], v2, s[48:51], s11 offen offset:2048 nt
  v_perm_b32 v18, v212, v208, s8
  v_perm_b32 v19, v220, v216, s8
  v_perm_b32 v20, v196, v192, s9
  v_perm_b32 v21, v204, v200, s9
  v_perm_b32 v22, v212, v208, s9
  v_perm_b32 v23, v220, v216, s9
  v_perm_b32 v24, v197, v193, s8
  v_perm_b32 v25, v205, v201, s8
  v_perm_b32 v26, v213, v209, s8
  v_perm_b32 v27, v221, v217, s8
  v_perm_b32 v28, v197, v193, s9
  v_perm_b32 v29, v205, v201, s9
  v_perm_b32 v30, v213, v209, s9
  v_perm_b32 v31, v221, v217, s9
  s_waitcnt lgkmcnt(0)
  ds_read_b128 v[12:15], v5 offset:128
  v_mfma_f32_16x16x32_bf16 v[32:35], v[8:11], v[16:19], 0
  v_mfma_f32_16x16x32_bf16 v[36:39], v[8:11], v[20:23], 0
  v_perm_b32 v16, v198, v194, s8
  v_perm_b32 v17, v206, v202, s8
  s_waitcnt vmcnt(5)
  s_cbranch_vccnz L_b_25
  s_waitcnt vmcnt(4)
L_b_25:
  buffer_load_dwordx4 v[188:191], v2, s[48:51], s11 offen offset:3072 nt
  v_perm_b32 v18, v214, v210, s8
  v_perm_b32 v19, v222, v218, s8
  v_perm_b32 v20, v198, v194, s9
  v_perm_b32 v21, v206, v202, s9
  v_perm_b32 v22, v214, v210, s9
  v_perm_b32 v23, v222, v218, s9
  v_mfma_f32_16x16x32_bf16 v[40:43], v[8:11], v[24:27], 0
  v_mfma_f32_16x16x32_bf16 v[44:47], v[8:11], v[28:31], 0
  v_perm_b32 v24, v199, v195, s8
  v_perm_b32 v25, v207, v203, s8
  v_perm_b32 v26, v215, v211, s8
  v_perm_b32 v27, v223, v219, s8
  v_perm_b32 v28, v199, v195, s9
  v_perm_b32 v29, v207, v203, s9
  v_perm_b32 v30, v215, v211, s9
  v_perm_b32 v31, v223, v219, s9
  v_mfma_f32_16x16x32_bf16 v[48:51], v[8:11], v[16:19], 0
  v_mfma_f32_16x16x32_bf16 v[52:55], v[8:11], v[20:23], 0
  v_mfma_f32_16x16x32_bf16 v[56:59], v[8:11], v[24:27], 0
  v_mfma_f32_16x16x32_bf16 v[60:63], v[8:11], v[28:31], 0
  s_add_u32 s10, s10, s84
  s_waitcnt vmcnt(5)
  s_cbranch_vccnz L_b_26
  s_waitcnt vmcnt(4)
L_b_26:
  buffer_load_dwordx4 v[192:195], v2, s[48:51], s10 offen offset:0 nt
  v_perm_b32 v16, v228, v224, s8
  v_perm_b32 v17, v236, v232, s8
  v_perm_b32 v18, v244, v240, s8
  v_perm_b32 v19, v252, v248, s8
  v_perm_b32 v20, v228, v224, s9
  v_perm_b32 v21, v236, v232, s9
  v_perm_b32 v22, v244, v240, s9
  v_perm_b32 v23, v252, v248, s9
  v_perm_b32 v24, v229, v225, s8
  v_perm_b32 v25, v237, v233, s8
  s_waitcnt vmcnt(5)
  s_cbranch_vccnz L_b_27
  s_waitcnt vmcnt(4)
L_b_27:
  buffer_load_dwordx4 v[196:199], v2, s[48:51], s10 offen offset:1024 nt
  v_perm_b32 v26, v245, v241, s8
  v_perm_b32 v27, v253, v249, s8
  v_perm_b32 v28, v229, v225, s9
  v_perm_b32 v29, v237, v233, s9
  v_perm_b32 v30, v245, v241, s9
  v_perm_b32 v31, v253, v249, s9
  s_waitcnt lgkmcnt(0)
  ds_read_b128 v[8:11], v5 offset:256
  v_mfma_f32_16x16x32_bf16 v[32:35], v[12:15], v[16:19], v[32:35]
  v_mfma_f32_16x16x32_bf16 v[36:39], v[12:15], v[20:23], v[36:39]
  v_perm_b32 v16, v230, v226, s8
  s_waitcnt vmcnt(5)
  s_cbranch_vccnz L_b_28
  s_waitcnt vmcnt(4)
L_b_28:
  buffer_load_dwordx4 v[200:203], v2, s[48:51], s10 offen offset:2048 nt
  v_perm_b32 v17, v238, v234, s8
  v_perm_b32 v18, v246, v242, s8
  v_perm_b32 v19, v254, v250, s8
  v_perm_b32 v20, v230, v226, s9
  v_perm_b32 v21, v238, v234, s9
  v_perm_b32 v22, v246, v242, s9
  v_perm_b32 v23, v254, v250, s9
  v_mfma_f32_16x16x32_bf16 v[40:43], v[12:15], v[24:27], v[40:43]
  v_mfma_f32_16x16x32_bf16 v[44:47], v[12:15], v[28:31], v[44:47]
  v_perm_b32 v24, v231, v227, s8
  s_waitcnt vmcnt(5)
  s_cbranch_vccnz L_b_29
  s_waitcnt vmcnt(4)
L_b_29:
  buffer_load_dwordx4 v[204:207], v2, s[48:51], s10 offen offset:3072 nt
  v_perm_b32 v25, v239, v235, s8
  v_perm_b32 v26, v247, v243, s8
  v_perm_b32 v27, v255, v251, s8
  v_perm_b32 v28, v231, v227, s9
  v_perm_b32 v29, v239, v235, s9
  v_perm_b32 v30, v247, v243, s9
  v_perm_b32 v31, v255, v251, s9
  v_mfma_f32_16x16x32_bf16 v[48:51], v[12:15], v[16:19], v[48:51]
  v_mfma_f32_16x16x32_bf16 v[52:55], v[12:15], v[20:23], v[52:55]
  v_mfma_f32_16x16x32_bf16 v[56:59], v[12:15], v[24:27], v[56:59]
  v_mfma_f32_16x16x32_bf16 v[60:63], v[12:15], v[28:31], v[60:63]
  s_add_u32 s11, s10, 16384
  s_waitcnt vmcnt(5)
  s_cbranch_vccnz L_b_30
  s_waitcnt vmcnt(4)
L_b_30:
  buffer_load_dwordx4 v[208:211], v2, s[48:51], s11 offen offset:0 nt
  v_perm_b32 v16, v68, v64, s8
  v_perm_b32 v17, v76, v72, s8
  v_perm_b32 v18, v84, v80, s8
  v_perm_b32 v19, v92, v88, s8
  v_perm_b32 v20, v68, v64, s9
  v_perm_b32 v21, v76, v72, s9
  v_perm_b32 v22, v84, v80, s9
  v_perm_b32 v23, v92, v88, s9
  v_perm_b32 v24, v69, v65, s8
  v_perm_b32 v25, v77, v73, s8
  s_waitcnt vmcnt(5)
  s_cbranch_vccnz L_b_31
  s_waitcnt vmcnt(4)
L_b_31:
  buffer_load_dwordx4 v[212:215], v2, s[48:51], s11 offen offset:1024 nt
  v_perm_b32 v26, v85, v81, s8
  v_perm_b32 v27, v93, v89, s8
  v_perm_b32 v28, v69, v65, s9
  v_perm_b32 v29, v77, v73, s9
  v_perm_b32 v30, v85, v81, s9
  v_perm_b32 v31, v93, v89, s9
  s_waitcnt lgkmcnt(0)
  ds_read_b128 v[12:15], v5 offset:384
  v_mfma_f32_16x16x32_bf16 v[32:35], v[8:11], v[16:19], v[32:35]
  v_mfma_f32_16x16x32_bf16 v[36:39], v[8:11], v[20:23], v[36:39]
  v_perm_b32 v16, v70, v66, s8
  s_waitcnt vmcnt(5)
  s_cbranch_vccnz L_b_32
  s_waitcnt vmcnt(4)
L_b_32:
  buffer_load_dwordx4 v[216:219], v2, s[48:51], s11 offen offset:2048 nt
  v_perm_b32 v17, v78, v74, s8
  v_perm_b32 v18, v86, v82, s8
  v_perm_b32 v19, v94, v90, s8
  v_perm_b32 v20, v70, v66, s9
  v_perm_b32 v21, v78, v74, s9
  v_perm_b32 v22, v86, v82, s9
  v_perm_b32 v23, v94, v90, s9
  v_mfma_f32_16x16x32_bf16 v[40:43], v[8:11], v[24:27], v[40:43]
  v_mfma_f32_16x16x32_bf16 v[44:47], v[8:11], v[28:31], v[44:47]
  v_perm_b32 v24, v71, v67, s8
  s_waitcnt vmcnt(5)
  s_cbranch_vccnz L_b_33
  s_waitcnt vmcnt(4)
L_b_33:
  buffer_load_dwordx4 v[220:223], v2, s[48:51], s11 offen offset:3072 nt
  v_perm_b32 v25, v79, v75, s8
  v_perm_b32 v26, v87, v83, s8
  v_perm_b32 v27, v95, v91, s8
  v_perm_b32 v28, v71, v67, s9
  v_perm_b32 v29, v79, v75, s9
  v_perm_b32 v30, v87, v83, s9
  v_perm_b32 v31, v95, v91, s9
  v_mfma_f32_16x16x32_bf16 v[48:51], v[8:11], v[16:19], v[48:51]
  v_mfma_f32_16x16x32_bf16 v[52:55], v[8:11], v[20:23], v[52:55]
  v_mfma_f32_16x16x32_bf16 v[56:59], v[8:11], v[24:27], v[56:59]
  v_mfma_f32_16x16x32_bf16 v[60:63], v[8:11], v[28:31], v[60:63]
  s_add_u32 s10, s10, s84
  s_waitcnt vmcnt(5)
  s_cbranch_vccnz L_b_34
  s_waitcnt vmcnt(4)
L_b_34:
  buffer_load_dwordx4 v[224:227], v2, s[48:51], s10 offen offset:0 nt
  v_perm_b32 v16, v100, v96, s8
  v_perm_b32 v17, v108, v104, s8
  v_perm_b32 v18, v116, v112, s8
  v_perm_b32 v19, v124, v120, s8
  v_perm_b32 v20, v100, v96, s9
  v_perm_b32 v21, v108, v104, s9
  v_perm_b32 v22, v116, v112, s9
  v_perm_b32 v23, v124, v120, s9
  v_perm_b32 v24, v101, v97, s8
  v_perm_b32 v25, v109, v105, s8
  s_waitcnt vmcnt(5)
  s_cbranch_vccnz L_b_35
  s_waitcnt vmcnt(4)
L_b_35:
  buffer_load_dwordx4 v[228:231], v2, s[48:51], s10 offen offset:1024 nt
  v_perm_b32 v26, v117, v113, s8
  v_perm_b32 v27, v125, v121, s8
  v_perm_b32 v28, v101, v97, s9
  v_perm_b32 v29, v109, v105, s9
  v_perm_b32 v30, v117, v113, s9
  v_perm_b32 v31, v125, v121, s9
  s_waitcnt lgkmcnt(0)
  ds_read_b128 v[8:11], v5 offset:512
  v_mfma_f32_16x16x32_bf16 v[32:35], v[12:15], v[16:19], v[32:35]
  v_mfma_f32_16x16x32_bf16 v[36:39], v[12:15], v[20:23], v[36:39]
  v_perm_b32 v16, v102, v98, s8
  s_waitcnt vmcnt(5)
  s_cbranch_vccnz L_b_36
  s_waitcnt vmcnt(4)
L_b_36:
  buffer_load_dwordx4 v[232:235], v2, s[48:51], s10 offen offset:2048 nt
  v_perm_b32 v17, v110, v106, s8
  v_perm_b32 v18, v118, v114, s8
  v_perm_b32 v19, v126, v122, s8
  v_perm_b32 v20, v102, v98, s9
  v_perm_b32 v21, v110, v106, s9
  v_perm_b32 v22, v118, v114, s9
  v_perm_b32 v23, v126, v122, s9
  v_mfma_f32_16x16x32_bf16 v[40:43], v[12:15], v[24:27], v[40:43]
  v_mfma_f32_16x16x32_bf16 v[44:47], v[12:15], v[28:31], v[44:47]
  v_perm_b32 v24, v103, v99, s8
  s_waitcnt vmcnt(5)
  s_cbranch_vccnz L_b_37
  s_waitcnt vmcnt(4)
L_b_37:
  buffer_load_dwordx4 v[236:239], v2, s[48:51], s10 offen offset:3072 nt
  v_perm_b32 v25, v111, v107, s8
  v_perm_b32 v26, v119, v115, s8
  v_perm_b32 v27, v127, v123, s8
  v_perm_b32 v28, v103, v99, s9
  v_perm_b32 v29, v111, v107, s9
  v_perm_b32 v30, v119, v115, s9
  v_perm_b32 v31, v127, v123, s9
  v_mfma_f32_16x16x32_bf16 v[48:51], v[12:15], v[16:19], v[48:51]
  v_mfma_f32_16x16x32_bf16 v[52:55], v[12:15], v[20:23], v[52:55]
  v_mfma_f32_16x16x32_bf16 v[56:59], v[12:15], v[24:27], v[56:59]
  v_mfma_f32_16x16x32_bf16 v[60:63], v[12:15], v[28:31], v[60:63]
  s_add_u32 s11, s10, 16384
  s_waitcnt vmcnt(5)
  s_cbranch_vccnz L_b_38
  s_waitcnt vmcnt(4)
L_b_38:
  buffer_load_dwordx4 v[240:243], v2, s[48:51], s11 offen offset:0 nt
  v_perm_b32 v16, v132, v128, s8
  v_perm_b32 v17, v140, v136, s8
  v_perm_b32 v18, v148, v144, s8
  v_perm_b32 v19, v156, v152, s8
  v_perm_b32 v20, v132, v128, s9
  v_perm_b32 v21, v140, v136, s9
  v_perm_b32 v22, v148, v144, s9
  v_perm_b32 v23, v156, v152, s9
  v_perm_b32 v24, v133, v129, s8
  v_perm_b32 v25, v141, v137, s8
  s_waitcnt vmcnt(5)
  s_cbranch_vccnz L_b_39
  s_waitcnt vmcnt(4)
L_b_39:
  buffer_load_dwordx4 v[244:247], v2, s[48:51], s11 offen offset:1024 nt
  v_perm_b32 v26, v149, v145, s8
  v_perm_b32 v27, v157, v153, s8
  v_perm_b32 v28, v133, v129, s9
  v_perm_b32 v29, v141, v137, s9
  v_perm_b32 v30, v149, v145, s9
  v_perm_b32 v31, v157, v153, s9
  s_waitcnt lgkmcnt(0)
  ds_read_b128 v[12:15], v5 offset:640
  v_mfma_f32_16x16x32_bf16 v[32:35], v[8:11], v[16:19], v[32:35]
  v_mfma_f32_16x16x32_bf16 v[36:39], v[8:11], v[20:23], v[36:39]
  v_perm_b32 v16, v134, v130, s8
  s_waitcnt vmcnt(5)
  s_cbranch_vccnz L_b_40
  s_waitcnt vmcnt(4)
L_b_40:
  buffer_load_dwordx4 v[248:251], v2, s[48:51], s11 offen offset:2048 nt
  v_perm_b32 v17, v142, v138, s8
  v_perm_b32 v18, v150, v146, s8
  v_perm_b32 v19, v158, v154, s8
  v_perm_b32 v20, v134, v130, s9
  v_perm_b32 v21, v142, v138, s9
  v_perm_b32 v22, v150, v146, s9
  v_perm_b32 v23, v158, v154, s9
  v_mfma_f32_16x16x32_bf16 v[40:43], v[8:11], v[24:27], v[40:43]
  v_mfma_f32_16x16x32_bf16 v[44:47], v[8:11], v[28:31], v[44:47]
  v_perm_b32 v24, v135, v131, s8
  s_waitcnt vmcnt(5)
  s_cbranch_vccnz L_b_41
  s_waitcnt vmcnt(4)
L_b_41:
  buffer_load_dwordx4 v[252:255], v2, s[48:51], s11 offen offset:3072 nt
  v_perm_b32 v25, v143, v139, s8
  v_perm_b32 v26, v151, v147, s8
  v_perm_b32 v27, v159, v155, s8
  v_perm_b32 v28, v135, v131, s9
  v_perm_b32 v29, v143, v139, s9
  v_perm_b32 v30, v151, v147, s9
  v_perm_b32 v31, v159, v155, s9
  v_mfma_f32_16x16x32_bf16 v[48:51], v[8:11], v[16:19], v[48:51]
  v_mfma_f32_16x16x32_bf16 v[52:55], v[8:11], v[20:23], v[52:55]
  v_mfma_f32_16x16x32_bf16 v[56:59], v[8:11], v[24:27], v[56:59]
  v_mfma_f32_16x16x32_bf16 v[60:63], v[8:11], v[28:31], v[60:63]
  s_add_u32 s10, s10, s84
  s_waitcnt vmcnt(5)
  s_cbranch_vccnz L_b_42
  s_waitcnt vmcnt(4)
L_b_42:
  buffer_load_dwordx4 v[64:67], v2, s[48:51], s10 offen offset:0 nt
  v_perm_b32 v16, v164, v160, s8
  v_perm_b32 v17, v172, v168, s8
  v_perm_b32 v18, v180, v176, s8
  v_perm_b32 v19, v188, v184, s8
  v_perm_b32 v20, v164, v160, s9
  v_perm_b32 v21, v172, v168, s9
  v_perm_b32 v22, v180, v176, s9
  v_perm_b32 v23, v188, v184, s9
  v_perm_b32 v24, v165, v161, s8
  v_perm_b32 v25, v173, v169, s8
  s_waitcnt vmcnt(5)
  s_cbranch_vccnz L_b_43
  s_waitcnt vmcnt(4)
L_b_43:
  buffer_load_dwordx4 v[68:71], v2, s[48:51], s10 offen offset:1024 nt
  v_perm_b32 v26, v181, v177, s8
  v_perm_b32 v27, v189, v185, s8
  v_perm_b32 v28, v165, v161, s9
  v_perm_b32 v29, v173, v169, s9
  v_perm_b32 v30, v181, v177, s9
  v_perm_b32 v31, v189, v185, s9
  s_waitcnt lgkmcnt(0)
  ds_read_b128 v[8:11], v5 offset:768
  v_mfma_f32_16x16x32_bf16 v[32:35], v[12:15], v[16:19], v[32:35]
  v_mfma_f32_16x16x32_bf16 v[36:39], v[12:15], v[20:23], v[36:39]
  v_perm_b32 v16, v166, v162, s8
  s_waitcnt vmcnt(5)
  s_cbranch_vccnz L_b_44
  s_waitcnt vmcnt(4)
L_b_44:
  buffer_load_dwordx4 v[72:75], v2, s[48:51], s10 offen offset:2048 nt
  v_perm_b32 v17, v174, v170, s8
  v_perm_b32 v18, v182, v178, s8
  v_perm_b32 v19, v190, v186, s8
  v_perm_b32 v20, v166, v162, s9
  v_perm_b32 v21, v174, v170, s9
  v_perm_b32 v22, v182, v178, s9
  v_perm_b32 v23, v190, v186, s9
  v_mfma_f32_16x16x32_bf16 v[40:43], v[12:15], v[24:27], v[40:43]
  v_mfma_f32_16x16x32_bf16 v[44:47], v[12:15], v[28:31], v[44:47]
  v_perm_b32 v24, v167, v163, s8
  s_waitcnt vmcnt(5)
  s_cbranch_vccnz L_b_45
  s_waitcnt vmcnt(4)
L_b_45:
  buffer_load_dwordx4 v[76:79], v2, s[48:51], s10 offen offset:3072 nt
  v_perm_b32 v25, v175, v171, s8
  v_perm_b32 v26, v183, v179, s8
  v_perm_b32 v27, v191, v187, s8
  v_perm_b32 v28, v167, v163, s9
  v_perm_b32 v29, v175, v171, s9
  v_perm_b32 v30, v183, v179, s9
  v_perm_b32 v31, v191, v187, s9
  v_mfma_f32_16x16x32_bf16 v[48:51], v[12:15], v[16:19], v[48:51]
  v_mfma_f32_16x16x32_bf16 v[52:55], v[12:15], v[20:23], v[52:55]
  v_mfma_f32_16x16x32_bf16 v[56:59], v[12:15], v[24:27], v[56:59]
  v_mfma_f32_16x16x32_bf16 v[60:63], v[12:15], v[28:31], v[60:63]
  s_add_u32 s11, s10, 16384
  s_waitcnt vmcnt(5)
  s_cbranch_vccnz L_b_46
  s_waitcnt vmcnt(4)
L_b_46:
  buffer_load_dwordx4 v[80:83], v2, s[48:51], s11 offen offset:0 nt
  v_perm_b32 v16, v196, v192, s8
  v_perm_b32 v17, v204, v200, s8
  v_perm_b32 v18, v212, v208, s8
  v_perm_b32 v19, v220, v216, s8
  v_perm_b32 v20, v196, v192, s9
  v_perm_b32 v21, v204, v200, s9
  v_perm_b32 v22, v212, v208, s9
  v_perm_b32 v23, v220, v216, s9
  v_perm_b32 v24, v197, v193, s8
  v_perm_b32 v25, v205, v201, s8
  s_waitcnt vmcnt(5)
  s_cbranch_vccnz L_b_47
  s_waitcnt vmcnt(4)
L_b_47:
  buffer_load_dwordx4 v[84:87], v2, s[48:51], s11 offen offset:1024 nt
  v_perm_b32 v26, v213, v209, s8
  v_perm_b32 v27, v221, v217, s8
  v_perm_b32 v28, v197, v193, s9
  v_perm_b32 v29, v205, v201, s9
  v_perm_b32 v30, v213, v209, s9
  v_perm_b32 v31, v221, v217, s9
  s_waitcnt lgkmcnt(0)
  ds_read_b128 v[12:15], v5 offset:896
  v_mfma_f32_16x16x32_bf16 v[32:35], v[8:11], v[16:19], v[32:35]
  v_mfma_f32_16x16x32_bf16 v[36:39], v[8:11], v[20:23], v[36:39]
  v_perm_b32 v16, v198, v194, s8
  s_waitcnt vmcnt(5)
  s_cbranch_vccnz L_b_48
  s_waitcnt vmcnt(4)
L_b_48:
  buffer_load_dwordx4 v[88:91], v2, s[48:51], s11 offen offset:2048 nt
  v_perm_b32 v17, v206, v202, s8
  v_perm_b32 v18, v214, v210, s8
  v_perm_b32 v19, v222, v218, s8
  v_perm_b32 v20, v198, v194, s9
  v_perm_b32 v21, v206, v202, s9
  v_perm_b32 v22, v214, v210, s9
  v_perm_b32 v23, v222, v218, s9
  v_mfma_f32_16x16x32_bf16 v[40:43], v[8:11], v[24:27], v[40:43]
  v_mfma_f32_16x16x32_bf16 v[44:47], v[8:11], v[28:31], v[44:47]
  v_perm_b32 v24, v199, v195, s8
  s_waitcnt vmcnt(5)
  s_cbranch_vccnz L_b_49
  s_waitcnt vmcnt(4)
L_b_49:
  buffer_load_dwordx4 v[92:95], v2, s[48:51], s11 offen offset:3072 nt
  v_perm_b32 v25, v207, v203, s8
  v_perm_b32 v26, v215, v211, s8
  v_perm_b32 v27, v223, v219, s8
  v_perm_b32 v28, v199, v195, s9
  v_perm_b32 v29, v207, v203, s9
  v_perm_b32 v30, v215, v211, s9
  v_perm_b32 v31, v223, v219, s9
  v_mfma_f32_16x16x32_bf16 v[48:51], v[8:11], v[16:19], v[48:51]
  v_mfma_f32_16x16x32_bf16 v[52:55], v[8:11], v[20:23], v[52:55]
  v_mfma_f32_16x16x32_bf16 v[56:59], v[8:11], v[24:27], v[56:59]
  v_mfma_f32_16x16x32_bf16 v[60:63], v[8:11], v[28:31], v[60:63]
  s_add_u32 s10, s10, s84
  s_waitcnt vmcnt(5)
  s_cbranch_vccnz L_b_50
  s_waitcnt vmcnt(4)
L_b_50:
  buffer_load_dwordx4 v[96:99], v2, s[48:51], s10 offen offset:0 nt
  v_perm_b32 v16, v228, v224, s8
  v_perm_b32 v17, v236, v232, s8
  v_perm_b32 v18, v244, v240, s8
  v_perm_b32 v19, v252, v248, s8
  v_perm_b32 v20, v228, v224, s9
  s_waitcnt vmcnt(5)
  s_cbranch_vccnz L_b_51
  s_waitcnt vmcnt(4)
L_b_51:
  buffer_load_dwordx4 v[100:103], v2, s[48:51], s10 offen offset:1024 nt
  v_perm_b32 v21, v236, v232, s9
  v_perm_b32 v22, v244, v240, s9
  v_perm_b32 v23, v252, v248, s9
  v_perm_b32 v24, v229, v225, s8
  v_perm_b32 v25, v237, v233, s8
  s_waitcnt vmcnt(5)
  s_cbranch_vccnz L_b_52
  s_waitcnt vmcnt(4)
L_b_52:
  buffer_load_dwordx4 v[104:107], v2, s[48:51], s10 offen offset:2048 nt
  v_perm_b32 v26, v245, v241, s8
  v_perm_b32 v27, v253, v249, s8
  v_perm_b32 v28, v229, v225, s9
  v_perm_b32 v29, v237, v233, s9
  v_perm_b32 v30, v245, v241, s9
  s_waitcnt vmcnt(5)
  s_cbranch_vccnz L_b_53
  s_waitcnt vmcnt(4)
L_b_53:
  buffer_load_dwordx4 v[108:111], v2, s[48:51], s10 offen offset:3072 nt
  v_perm_b32 v31, v253, v249, s9
  s_waitcnt lgkmcnt(0)
  ds_read_b128 v[8:11], v5 offset:1024
  v_mfma_f32_16x16x32_bf16 v[32:35], v[12:15], v[16:19], v[32:35]
  v_mfma_f32_16x16x32_bf16 v[36:39], v[12:15], v[20:23], v[36:39]
  v_perm_b32 v16, v230, v226, s8
  s_add_u32 s11, s10, 16384
  s_waitcnt vmcnt(5)
  s_cbranch_vccnz L_b_54
  s_waitcnt vmcnt(4)
L_b_54:
  buffer_load_dwordx4 v[112:115], v2, s[48:51], s11 offen offset:0 nt
  v_perm_b32 v17, v238, v234, s8
  v_perm_b32 v18, v246, v242, s8
  v_perm_b32 v19, v254, v250, s8
  v_perm_b32 v20, v230, v226, s9
  v_perm_b32 v21, v238, v234, s9
  s_waitcnt vmcnt(5)
  s_cbranch_vccnz L_b_55
  s_waitcnt vmcnt(4)
L_b_55:
  buffer_load_dwordx4 v[116:119], v2, s[48:51], s11 offen offset:1024 nt
  v_perm_b32 v22, v246, v242, s9
  v_perm_b32 v23, v254, v250, s9
  v_mfma_f32_16x16x32_bf16 v[40:43], v[12:15], v[24:27], v[40:43]
  v_mfma_f32_16x16x32_bf16 v[44:47], v[12:15], v[28:31], v[44:47]
  v_perm_b32 v24, v231, v227, s8
  s_waitcnt vmcnt(5)
  s_cbranch_vccnz L_b_56
  s_waitcnt vmcnt(4)
L_b_56:
  buffer_load_dwordx4 v[120:123], v2, s[48:51], s11 offen offset:2048 nt
  v_perm_b32 v25, v239, v235, s8
  v_perm_b32 v26, v247, v243, s8
  v_perm_b32 v27, v255, v251, s8
  v_perm_b32 v28, v231, v227, s9
  v_perm_b32 v29, v239, v235, s9
  s_waitcnt vmcnt(5)
  s_cbranch_vccnz L_b_57
  s_waitcnt vmcnt(4)
L_b_57:
  buffer_load_dwordx4 v[124:127], v2, s[48:51], s11 offen offset:3072 nt
  v_perm_b32 v30, v247, v243, s9
  v_perm_b32 v31, v255, v251, s9
  v_mfma_f32_16x16x32_bf16 v[48:51], v[12:15], v[16:19], v[48:51]
  v_mfma_f32_16x16x32_bf16 v[52:55], v[12:15], v[20:23], v[52:55]
  v_mfma_f32_16x16x32_bf16 v[56:59], v[12:15], v[24:27], v[56:59]
  v_mfma_f32_16x16x32_bf16 v[60:63], v[12:15], v[28:31], v[60:63]
  s_add_u32 s10, s10, s84
  s_waitcnt vmcnt(5)
  s_cbranch_vccnz L_b_58
  s_waitcnt vmcnt(4)
L_b_58:
  buffer_load_dwordx4 v[128:131], v2, s[48:51], s10 offen offset:0 nt
  v_perm_b32 v16, v68, v64, s8
  v_perm_b32 v17, v76, v72, s8
  v_perm_b32 v18, v84, v80, s8
  v_perm_b32 v19, v92, v88, s8
  v_perm_b32 v20, v68, v64, s9
  s_waitcnt vmcnt(5)
  s_cbranch_vccnz L_b_59
  s_waitcnt vmcnt(4)
L_b_59:
  buffer_load_dwordx4 v[132:135], v2, s[48:51], s10 offen offset:1024 nt
  v_perm_b32 v21, v76, v72, s9
  v_perm_b32 v22, v84, v80, s9
  v_perm_b32 v23, v92, v88, s9
  v_perm_b32 v24, v69, v65, s8
  v_perm_b32 v25, v77, v73, s8
  s_waitcnt vmcnt(5)
  s_cbranch_vccnz L_b_60
  s_waitcnt vmcnt(4)
L_b_60:
  buffer_load_dwordx4 v[136:139], v2, s[48:51], s10 offen offset:2048 nt
  v_perm_b32 v26, v85, v81, s8
  v_perm_b32 v27, v93, v89, s8
  v_perm_b32 v28, v69, v65, s9
  v_perm_b32 v29, v77, v73, s9
  v_perm_b32 v30, v85, v81, s9
  s_waitcnt vmcnt(5)
  s_cbranch_vccnz L_b_61
  s_waitcnt vmcnt(4)
L_b_61:
  buffer_load_dwordx4 v[140:143], v2, s[48:51], s10 offen offset:3072 nt
  v_perm_b32 v31, v93, v89, s9
  s_waitcnt lgkmcnt(0)
  ds_read_b128 v[12:15], v5 offset:1152
  v_mfma_f32_16x16x32_bf16 v[32:35], v[8:11], v[16:19], v[32:35]
  v_mfma_f32_16x16x32_bf16 v[36:39], v[8:11], v[20:23], v[36:39]
  v_perm_b32 v16, v70, v66, s8
  s_add_u32 s11, s10, 16384
  s_waitcnt vmcnt(5)
  s_cbranch_vccnz L_b_62
  s_waitcnt vmcnt(4)
L_b_62:
  buffer_load_dwordx4 v[144:147], v2, s[48:51], s11 offen offset:0 nt
  v_perm_b32 v17, v78, v74, s8
  v_perm_b32 v18, v86, v82, s8
  v_perm_b32 v19, v94, v90, s8
  v_perm_b32 v20, v70, v66, s9
  v_perm_b32 v21, v78, v74, s9
  s_waitcnt vmcnt(5)
  s_cbranch_vccnz L_b_63
  s_waitcnt vmcnt(4)
L_b_63:
  buffer_load_dwordx4 v[148:151], v2, s[48:51], s11 offen offset:1024 nt
  v_perm_b32 v22, v86, v82, s9
  v_perm_b32 v23, v94, v90, s9
  v_mfma_f32_16x16x32_bf16 v[40:43], v[8:11], v[24:27], v[40:43]
  v_mfma_f32_16x16x32_bf16 v[44:47], v[8:11], v[28:31], v[44:47]
  v_perm_b32 v24, v71, v67, s8
  s_waitcnt vmcnt(5)
  s_cbranch_vccnz L_b_64
  s_waitcnt vmcnt(4)
L_b_64:
  buffer_load_dwordx4 v[152:155], v2, s[48:51], s11 offen offset:2048 nt
  v_perm_b32 v25, v79, v75, s8
  v_perm_b32 v26, v87, v83, s8
  v_perm_b32 v27, v95, v91, s8
  v_perm_b32 v28, v71, v67, s9
  v_perm_b32 v29, v79, v75, s9
  s_waitcnt vmcnt(5)
  s_cbranch_vccnz L_b_65
  s_waitcnt vmcnt(4)
L_b_65:
  buffer_load_dwordx4 v[156:159], v2, s[48:51], s11 offen offset:3072 nt
  v_perm_b32 v30, v87, v83, s9
  v_perm_b32 v31, v95, v91, s9
  v_mfma_f32_16x16x32_bf16 v[48:51], v[8:11], v[16:19], v[48:51]
  v_mfma_f32_16x16x32_bf16 v[52:55], v[8:11], v[20:23], v[52:55]
  v_mfma_f32_16x16x32_bf16 v[56:59], v[8:11], v[24:27], v[56:59]
  v_mfma_f32_16x16x32_bf16 v[60:63], v[8:11], v[28:31], v[60:63]
  s_add_u32 s10, s10, s84
  s_waitcnt vmcnt(5)
  s_cbranch_vccnz L_b_66
  s_waitcnt vmcnt(4)
L_b_66:
  buffer_load_dwordx4 v[160:163], v2, s[48:51], s10 offen offset:0 nt
  v_perm_b32 v16, v100, v96, s8
  v_perm_b32 v17, v108, v104, s8
  v_perm_b32 v18, v116, v112, s8
  v_perm_b32 v19, v124, v120, s8
  v_perm_b32 v20, v100, v96, s9
  s_waitcnt vmcnt(5)
  s_cbranch_vccnz L_b_67
  s_waitcnt vmcnt(4)
L_b_67:
  buffer_load_dwordx4 v[164:167], v2, s[48:51], s10 offen offset:1024 nt
  v_perm_b32 v21, v108, v104, s9
  v_perm_b32 v22, v116, v112, s9
  v_perm_b32 v23, v124, v120, s9
  v_perm_b32 v24, v101, v97, s8
  v_perm_b32 v25, v109, v105, s8
  s_waitcnt vmcnt(5)
  s_cbranch_vccnz L_b_68
  s_waitcnt vmcnt(4)
L_b_68:
  buffer_load_dwordx4 v[168:171], v2, s[48:51], s10 offen offset:2048 nt
  v_perm_b32 v26, v117, v113, s8
  v_perm_b32 v27, v125, v121, s8
  v_perm_b32 v28, v101, v97, s9
  v_perm_b32 v29, v109, v105, s9
  v_perm_b32 v30, v117, v113, s9
  v_perm_b32 v31, v125, v121, s9
  s_waitcnt vmcnt(5)
  s_cbranch_vccnz L_b_69
  s_waitcnt vmcnt(4)
L_b_69:
  buffer_load_dwordx4 v[172:175], v2, s[48:51], s10 offen offset:3072 nt
  s_waitcnt lgkmcnt(0)
  v_add_u32 v5, s14, v5
  ds_read_b128 v[8:11], v5 offset:1280
  v_mfma_f32_16x16x32_bf16 v[32:35], v[12:15], v[16:19], v[32:35]
  v_mfma_f32_16x16x32_bf16 v[36:39], v[12:15], v[20:23], v[36:39]
  s_add_u32 s11, s10, 16384
  s_waitcnt vmcnt(5)
  s_cbranch_vccnz L_b_70
  s_waitcnt vmcnt(4)
L_b_70:
  buffer_load_dwordx4 v[176:179], v2, s[48:51], s11 offen offset:0 nt
  v_perm_b32 v16, v102, v98, s8
  v_perm_b32 v17, v110, v106, s8
  v_perm_b32 v18, v118, v114, s8
  v_perm_b32 v19, v126, v122, s8
  v_perm_b32 v20, v102, v98, s9
  s_waitcnt vmcnt(5)
  s_cbranch_vccnz L_b_71
  s_waitcnt vmcnt(4)
L_b_71:
  buffer_load_dwordx4 v[180:183], v2, s[48:51], s11 offen offset:1024 nt
  v_perm_b32 v21, v110, v106, s9
  v_perm_b32 v22, v118, v114, s9
  v_perm_b32 v23, v126, v122, s9
  v_mfma_f32_16x16x32_bf16 v[40:43], v[12:15], v[24:27], v[40:43]
  v_mfma_f32_16x16x32_bf16 v[44:47], v[12:15], v[28:31], v[44:47]
  v_perm_b32 v24, v103, v99, s8
  s_waitcnt vmcnt(5)
  s_cbranch_vccnz L_b_72
  s_waitcnt vmcnt(4)
L_b_72:
  buffer_load_dwordx4 v[184:187], v2, s[48:51], s11 offen offset:2048 nt
  v_perm_b32 v25, v111, v107, s8
  v_perm_b32 v26, v119, v115, s8
  v_perm_b32 v27, v127, v123, s8
  v_perm_b32 v28, v103, v99, s9
  v_perm_b32 v29, v111, v107, s9
  s_waitcnt vmcnt(5)
  s_cbranch_vccnz L_b_73
  s_waitcnt vmcnt(4)
L_b_73:
  buffer_load_dwordx4 v[188:191], v2, s[48:51], s11 offen offset:3072 nt
  v_perm_b32 v30, v119, v115, s9
  v_perm_b32 v31, v127, v123, s9
  v_mfma_f32_16x16x32_bf16 v[48:51], v[12:15], v[16:19], v[48:51]
  v_mfma_f32_16x16x32_bf16 v[52:55], v[12:15], v[20:23], v[52:55]
  v_mfma_f32_16x16x32_bf16 v[56:59], v[12:15], v[24:27], v[56:59]
  v_mfma_f32_16x16x32_bf16 v[60:63], v[12:15], v[28:31], v[60:63]
  s_add_u32 s10, s10, s84
  s_waitcnt vmcnt(7)
  buffer_load_dwordx4 v[192:195], v2, s[48:51], s10 offen offset:0 nt
  v_perm_b32 v16, v132, v128, s8
  v_perm_b32 v17, v140, v136, s8
  v_perm_b32 v18, v148, v144, s8
  v_perm_b32 v19, v156, v152, s8
  v_perm_b32 v20, v132, v128, s9
  s_waitcnt vmcnt(7)
  buffer_load_dwordx4 v[196:199], v2, s[48:51], s10 offen offset:1024 nt
  v_perm_b32 v21, v140, v136, s9
  v_perm_b32 v22, v148, v144, s9
  v_perm_b32 v23, v156, v152, s9
  v_perm_b32 v24, v133, v129, s8
  v_perm_b32 v25, v141, v137, s8
  s_waitcnt vmcnt(7)
  buffer_load_dwordx4 v[200:203], v2, s[48:51], s10 offen offset:2048 nt
  v_perm_b32 v26, v149, v145, s8
  v_perm_b32 v27, v157, v153, s8
  v_perm_b32 v28, v133, v129, s9
  v_perm_b32 v29, v141, v137, s9
  v_perm_b32 v30, v149, v145, s9
  s_waitcnt vmcnt(7)
  buffer_load_dwordx4 v[204:207], v2, s[48:51], s10 offen offset:3072 nt
  v_perm_b32 v31, v157, v153, s9
  s_waitcnt lgkmcnt(0)
  ds_read_b128 v[12:15], v5 offset:1408
  v_mfma_f32_16x16x32_bf16 v[32:35], v[8:11], v[16:19], v[32:35]
  v_mfma_f32_16x16x32_bf16 v[36:39], v[8:11], v[20:23], v[36:39]
  v_perm_b32 v16, v134, v130, s8
  s_add_u32 s11, s10, 16384
  s_waitcnt vmcnt(7)
  buffer_load_dwordx4 v[208:211], v2, s[48:51], s11 offen offset:0 nt
  v_perm_b32 v17, v142, v138, s8
  v_perm_b32 v18, v150, v146, s8
  v_perm_b32 v19, v158, v154, s8
  v_perm_b32 v20, v134, v130, s9
  v_perm_b32 v21, v142, v138, s9
  s_waitcnt vmcnt(7)
  buffer_load_dwordx4 v[212:215], v2, s[48:51], s11 offen offset:1024 nt
  v_perm_b32 v22, v150, v146, s9
  v_perm_b32 v23, v158, v154, s9
  v_mfma_f32_16x16x32_bf16 v[40:43], v[8:11], v[24:27], v[40:43]
  v_mfma_f32_16x16x32_bf16 v[44:47], v[8:11], v[28:31], v[44:47]
  v_perm_b32 v24, v135, v131, s8
  s_waitcnt vmcnt(7)
  buffer_load_dwordx4 v[216:219], v2, s[48:51], s11 offen offset:2048 nt
  v_perm_b32 v25, v143, v139, s8
  v_perm_b32 v26, v151, v147, s8
  v_perm_b32 v27, v159, v155, s8
  v_perm_b32 v28, v135, v131, s9
  v_perm_b32 v29, v143, v139, s9
  s_waitcnt vmcnt(7)
  buffer_load_dwordx4 v[220:223], v2, s[48:51], s11 offen offset:3072 nt
  v_perm_b32 v30, v151, v147, s9
  v_perm_b32 v31, v159, v155, s9
  v_mfma_f32_16x16x32_bf16 v[48:51], v[8:11], v[16:19], v[48:51]
  v_mfma_f32_16x16x32_bf16 v[52:55], v[8:11], v[20:23], v[52:55]
  v_mfma_f32_16x16x32_bf16 v[56:59], v[8:11], v[24:27], v[56:59]
  v_mfma_f32_16x16x32_bf16 v[60:63], v[8:11], v[28:31], v[60:63]
  s_add_u32 s10, s10, s84
  s_waitcnt vmcnt(7)
  buffer_load_dwordx4 v[224:227], v2, s[48:51], s10 offen offset:0 nt
  v_perm_b32 v16, v164, v160, s8
  v_perm_b32 v17, v172, v168, s8
  v_perm_b32 v18, v180, v176, s8
  v_perm_b32 v19, v188, v184, s8
  v_perm_b32 v20, v164, v160, s9
  s_waitcnt vmcnt(7)
  buffer_load_dwordx4 v[228:231], v2, s[48:51], s10 offen offset:1024 nt
  v_perm_b32 v21, v172, v168, s9
  v_perm_b32 v22, v180, v176, s9
  v_perm_b32 v23, v188, v184, s9
  v_perm_b32 v24, v165, v161, s8
  v_perm_b32 v25, v173, v169, s8
  s_waitcnt vmcnt(7)
  buffer_load_dwordx4 v[232:235], v2, s[48:51], s10 offen offset:2048 nt
  v_perm_b32 v26, v181, v177, s8
  v_perm_b32 v27, v189, v185, s8
  v_perm_b32 v28, v165, v161, s9
  v_perm_b32 v29, v173, v169, s9
  v_perm_b32 v30, v181, v177, s9
  s_waitcnt vmcnt(7)
  buffer_load_dwordx4 v[236:239], v2, s[48:51], s10 offen offset:3072 nt
  v_perm_b32 v31, v189, v185, s9
  s_waitcnt lgkmcnt(0)
  ds_read_b128 v[8:11], v5 offset:1536
  v_mfma_f32_16x16x32_bf16 v[32:35], v[12:15], v[16:19], v[32:35]
  v_mfma_f32_16x16x32_bf16 v[36:39], v[12:15], v[20:23], v[36:39]
  v_perm_b32 v16, v166, v162, s8
  s_add_u32 s11, s10, 16384
  s_waitcnt vmcnt(7)
  buffer_load_dwordx4 v[240:243], v2, s[48:51], s11 offen offset:0 nt
  v_perm_b32 v17, v174, v170, s8
  v_perm_b32 v18, v182, v178, s8
  v_perm_b32 v19, v190, v186, s8
  v_perm_b32 v20, v166, v162, s9
  v_perm_b32 v21, v174, v170, s9
  s_waitcnt vmcnt(7)
  buffer_load_dwordx4 v[244:247], v2, s[48:51], s11 offen offset:1024 nt
  v_perm_b32 v22, v182, v178, s9
  v_perm_b32 v23, v190, v186, s9
  v_mfma_f32_16x16x32_bf16 v[40:43], v[12:15], v[24:27], v[40:43]
  v_mfma_f32_16x16x32_bf16 v[44:47], v[12:15], v[28:31], v[44:47]
  v_perm_b32 v24, v167, v163, s8
  s_waitcnt vmcnt(7)
  buffer_load_dwordx4 v[248:251], v2, s[48:51], s11 offen offset:2048 nt
  v_perm_b32 v25, v175, v171, s8
  v_perm_b32 v26, v183, v179, s8
  v_perm_b32 v27, v191, v187, s8
  v_perm_b32 v28, v167, v163, s9
  v_perm_b32 v29, v175, v171, s9
  s_waitcnt vmcnt(7)
  buffer_load_dwordx4 v[252:255], v2, s[48:51], s11 offen offset:3072 nt
  v_perm_b32 v30, v183, v179, s9
  v_perm_b32 v31, v191, v187, s9
  v_mfma_f32_16x16x32_bf16 v[48:51], v[12:15], v[16:19], v[48:51]
  v_mfma_f32_16x16x32_bf16 v[52:55], v[12:15], v[20:23], v[52:55]
  v_mfma_f32_16x16x32_bf16 v[56:59], v[12:15], v[24:27], v[56:59]
  v_mfma_f32_16x16x32_bf16 v[60:63], v[12:15], v[28:31], v[60:63]
  s_add_u32 s10, s10, s84
  s_waitcnt vmcnt(7)
  buffer_load_dwordx4 v[64:67], v2, s[48:51], s10 offen offset:0 nt
  v_perm_b32 v16, v196, v192, s8
  v_perm_b32 v17, v204, v200, s8
  v_perm_b32 v18, v212, v208, s8
  v_perm_b32 v19, v220, v216, s8
  v_perm_b32 v20, v196, v192, s9
  s_waitcnt vmcnt(7)
  buffer_load_dwordx4 v[68:71], v2, s[48:51], s10 offen offset:1024 nt
  v_perm_b32 v21, v204, v200, s9
  v_perm_b32 v22, v212, v208, s9
  v_perm_b32 v23, v220, v216, s9
  v_perm_b32 v24, v197, v193, s8
  v_perm_b32 v25, v205, v201, s8
  s_waitcnt vmcnt(7)
  buffer_load_dwordx4 v[72:75], v2, s[48:51], s10 offen offset:2048 nt
  v_perm_b32 v26, v213, v209, s8
  v_perm_b32 v27, v221, v217, s8
  v_perm_b32 v28, v197, v193, s9
  v_perm_b32 v29, v205, v201, s9
  v_perm_b32 v30, v213, v209, s9
  s_waitcnt vmcnt(7)
  buffer_load_dwordx4 v[76:79], v2, s[48:51], s10 offen offset:3072 nt
  v_perm_b32 v31, v221, v217, s9
  s_waitcnt lgkmcnt(0)
  ds_read_b128 v[12:15], v5 offset:1664
  v_mfma_f32_16x16x32_bf16 v[32:35], v[8:11], v[16:19], v[32:35]
  v_mfma_f32_16x16x32_bf16 v[36:39], v[8:11], v[20:23], v[36:39]
  v_perm_b32 v16, v198, v194, s8
  s_add_u32 s11, s10, 16384
  s_waitcnt vmcnt(7)
  buffer_load_dwordx4 v[80:83], v2, s[48:51], s11 offen offset:0 nt
  v_perm_b32 v17, v206, v202, s8
  v_perm_b32 v18, v214, v210, s8
  v_perm_b32 v19, v222, v218, s8
  v_perm_b32 v20, v198, v194, s9
  v_perm_b32 v21, v206, v202, s9
  s_waitcnt vmcnt(7)
  buffer_load_dwordx4 v[84:87], v2, s[48:51], s11 offen offset:1024 nt
  v_perm_b32 v22, v214, v210, s9
  v_perm_b32 v23, v222, v218, s9
  v_mfma_f32_16x16x32_bf16 v[40:43], v[8:11], v[24:27], v[40:43]
  v_mfma_f32_16x16x32_bf16 v[44:47], v[8:11], v[28:31], v[44:47]
  v_perm_b32 v24, v199, v195, s8
  s_waitcnt vmcnt(7)
  buffer_load_dwordx4 v[88:91], v2, s[48:51], s11 offen offset:2048 nt
  v_perm_b32 v25, v207, v203, s8
  v_perm_b32 v26, v215, v211, s8
  v_perm_b32 v27, v223, v219, s8
  v_perm_b32 v28, v199, v195, s9
  v_perm_b32 v29, v207, v203, s9
  s_waitcnt vmcnt(7)
  buffer_load_dwordx4 v[92:95], v2, s[48:51], s11 offen offset:3072 nt
  v_perm_b32 v30, v215, v211, s9
  v_perm_b32 v31, v223, v219, s9
  v_mfma_f32_16x16x32_bf16 v[48:51], v[8:11], v[16:19], v[48:51]
  v_mfma_f32_16x16x32_bf16 v[52:55], v[8:11], v[20:23], v[52:55]
  v_mfma_f32_16x16x32_bf16 v[56:59], v[8:11], v[24:27], v[56:59]
  v_mfma_f32_16x16x32_bf16 v[60:63], v[8:11], v[28:31], v[60:63]
  s_add_u32 s10, s10, s84
  v_mov_b32 v1, 160328
  ds_write_b32 v1, v1 offset:20
  s_bitcmp0_b32 s79, 0
  s_cbranch_scc1 L_h_74
  s_waitcnt vmcnt(7)
  buffer_load_dwordx4 v[96:99], v2, s[48:51], s10 offen offset:0 nt
L_h_74:
  v_perm_b32 v16, v228, v224, s8
  v_perm_b32 v17, v236, v232, s8
  v_perm_b32 v18, v244, v240, s8
  v_perm_b32 v19, v252, v248, s8
  v_perm_b32 v20, v228, v224, s9
  s_bitcmp0_b32 s79, 1
  s_cbranch_scc1 L_h_75
  s_waitcnt vmcnt(7)
  buffer_load_dwordx4 v[100:103], v2, s[48:51], s10 offen offset:1024 nt
L_h_75:
  v_perm_b32 v21, v236, v232, s9
  v_perm_b32 v22, v244, v240, s9
  v_perm_b32 v23, v252, v248, s9
  v_perm_b32 v24, v229, v225, s8
  v_perm_b32 v25, v237, v233, s8
  s_bitcmp0_b32 s79, 2
  s_cbranch_scc1 L_h_76
  s_waitcnt vmcnt(7)
  buffer_load_dwordx4 v[104:107], v2, s[48:51], s10 offen offset:2048 nt
L_h_76:
  v_perm_b32 v26, v245, v241, s8
  v_perm_b32 v27, v253, v249, s8
  v_perm_b32 v28, v229, v225, s9
  v_perm_b32 v29, v237, v233, s9
  v_perm_b32 v30, v245, v241, s9
  s_bitcmp0_b32 s79, 3
  s_cbranch_scc1 L_h_77
  s_waitcnt vmcnt(7)
  buffer_load_dwordx4 v[108:111], v2, s[48:51], s10 offen offset:3072 nt
L_h_77:
  v_perm_b32 v31, v253, v249, s9
  s_waitcnt lgkmcnt(0)
  ds_read_b128 v[8:11], v5 offset:1792
  v_mfma_f32_16x16x32_bf16 v[32:35], v[12:15], v[16:19], v[32:35]
  v_mfma_f32_16x16x32_bf16 v[36:39], v[12:15], v[20:23], v[36:39]
  v_perm_b32 v16, v230, v226, s8
  s_add_u32 s11, s10, 16384
  s_bitcmp0_b32 s79, 4
  s_cbranch_scc1 L_h_78
  s_waitcnt vmcnt(7)
  buffer_load_dwordx4 v[112:115], v2, s[48:51], s11 offen offset:0 nt
L_h_78:
  v_perm_b32 v17, v238, v234, s8
  v_perm_b32 v18, v246, v242, s8
  v_perm_b32 v19, v254, v250, s8
  v_perm_b32 v20, v230, v226, s9
  v_perm_b32 v21, v238, v234, s9
  s_bitcmp0_b32 s79, 5
  s_cbranch_scc1 L_h_79
  s_waitcnt vmcnt(7)
  buffer_load_dwordx4 v[116:119], v2, s[48:51], s11 offen offset:1024 nt
L_h_79:
  v_perm_b32 v22, v246, v242, s9
  v_perm_b32 v23, v254, v250, s9
  v_mfma_f32_16x16x32_bf16 v[40:43], v[12:15], v[24:27], v[40:43]
  v_mfma_f32_16x16x32_bf16 v[44:47], v[12:15], v[28:31], v[44:47]
  v_perm_b32 v24, v231, v227, s8
  s_bitcmp0_b32 s79, 6
  s_cbranch_scc1 L_h_80
  s_waitcnt vmcnt(7)
  buffer_load_dwordx4 v[120:123], v2, s[48:51], s11 offen offset:2048 nt
L_h_80:
  v_perm_b32 v25, v239, v235, s8
  v_perm_b32 v26, v247, v243, s8
  v_perm_b32 v27, v255, v251, s8
  v_perm_b32 v28, v231, v227, s9
  v_perm_b32 v29, v239, v235, s9
  s_bitcmp0_b32 s79, 7
  s_cbranch_scc1 L_h_81
  s_waitcnt vmcnt(7)
  buffer_load_dwordx4 v[124:127], v2, s[48:51], s11 offen offset:3072 nt
L_h_81:
  v_perm_b32 v30, v247, v243, s9
  v_perm_b32 v31, v255, v251, s9
  v_mfma_f32_16x16x32_bf16 v[48:51], v[12:15], v[16:19], v[48:51]
  v_mfma_f32_16x16x32_bf16 v[52:55], v[12:15], v[20:23], v[52:55]
  v_mfma_f32_16x16x32_bf16 v[56:59], v[12:15], v[24:27], v[56:59]
  v_mfma_f32_16x16x32_bf16 v[60:63], v[12:15], v[28:31], v[60:63]
  s_add_u32 s10, s10, s84
  s_cmp_eq_u32 s83, 1
  s_cbranch_scc1 L_drain15
  s_bitcmp0_b32 s78, 0
  s_cbranch_scc1 L_h_82
  s_waitcnt vmcnt(7)
  buffer_load_dwordx4 v[128:131], v2, s[48:51], s10 offen offset:0 nt
L_h_82:
  v_perm_b32 v16, v68, v64, s8
  v_perm_b32 v17, v76, v72, s8
  v_perm_b32 v18, v84, v80, s8
  v_perm_b32 v19, v92, v88, s8
  v_perm_b32 v20, v68, v64, s9
  s_bitcmp0_b32 s78, 1
  s_cbranch_scc1 L_h_83
  s_waitcnt vmcnt(7)
  buffer_load_dwordx4 v[132:135], v2, s[48:51], s10 offen offset:1024 nt
L_h_83:
  v_perm_b32 v21, v76, v72, s9
  v_perm_b32 v22, v84, v80, s9
  v_perm_b32 v23, v92, v88, s9
  v_perm_b32 v24, v69, v65, s8
  v_perm_b32 v25, v77, v73, s8
  s_bitcmp0_b32 s78, 2
  s_cbranch_scc1 L_h_84
  s_waitcnt vmcnt(7)
  buffer_load_dwordx4 v[136:139], v2, s[48:51], s10 offen offset:2048 nt
L_h_84:
  v_perm_b32 v26, v85, v81, s8
  v_perm_b32 v27, v93, v89, s8
  v_perm_b32 v28, v69, v65, s9
  v_perm_b32 v29, v77, v73, s9
  v_perm_b32 v30, v85, v81, s9
  s_bitcmp0_b32 s78, 3
  s_cbranch_scc1 L_h_85
  s_waitcnt vmcnt(7)
  buffer_load_dwordx4 v[140:143], v2, s[48:51], s10 offen offset:3072 nt
L_h_85:
  v_perm_b32 v31, v93, v89, s9
  s_waitcnt lgkmcnt(0)
  ds_read_b128 v[12:15], v5 offset:1920
  v_mfma_f32_16x16x32_bf16 v[32:35], v[8:11], v[16:19], v[32:35]
  v_mfma_f32_16x16x32_bf16 v[36:39], v[8:11], v[20:23], v[36:39]
  v_perm_b32 v16, v70, v66, s8
  s_add_u32 s11, s10, 16384
  s_bitcmp0_b32 s78, 4
  s_cbranch_scc1 L_h_86
  s_waitcnt vmcnt(7)
  buffer_load_dwordx4 v[144:147], v2, s[48:51], s11 offen offset:0 nt
L_h_86:
  v_perm_b32 v17, v78, v74, s8
  v_perm_b32 v18, v86, v82, s8
  v_perm_b32 v19, v94, v90, s8
  v_perm_b32 v20, v70, v66, s9
  v_perm_b32 v21, v78, v74, s9
  s_bitcmp0_b32 s78, 5
  s_cbranch_scc1 L_h_87
  s_waitcnt vmcnt(7)
  buffer_load_dwordx4 v[148:151], v2, s[48:51], s11 offen offset:1024 nt
L_h_87:
  v_perm_b32 v22, v86, v82, s9
  v_perm_b32 v23, v94, v90, s9
  v_mfma_f32_16x16x32_bf16 v[40:43], v[8:11], v[24:27], v[40:43]
  v_mfma_f32_16x16x32_bf16 v[44:47], v[8:11], v[28:31], v[44:47]
  v_perm_b32 v24, v71, v67, s8
  s_bitcmp0_b32 s78, 6
  s_cbranch_scc1 L_h_88
  s_waitcnt vmcnt(7)
  buffer_load_dwordx4 v[152:155], v2, s[48:51], s11 offen offset:2048 nt
L_h_88:
  v_perm_b32 v25, v79, v75, s8
  v_perm_b32 v26, v87, v83, s8
  v_perm_b32 v27, v95, v91, s8
  v_perm_b32 v28, v71, v67, s9
  v_perm_b32 v29, v79, v75, s9
  s_bitcmp0_b32 s78, 7
  s_cbranch_scc1 L_h_89
  s_waitcnt vmcnt(7)
  buffer_load_dwordx4 v[156:159], v2, s[48:51], s11 offen offset:3072 nt
L_h_89:
  v_perm_b32 v30, v87, v83, s9
  v_perm_b32 v31, v95, v91, s9
  v_mfma_f32_16x16x32_bf16 v[48:51], v[8:11], v[16:19], v[48:51]
  v_mfma_f32_16x16x32_bf16 v[52:55], v[8:11], v[20:23], v[52:55]
  v_mfma_f32_16x16x32_bf16 v[56:59], v[8:11], v[24:27], v[56:59]
  v_mfma_f32_16x16x32_bf16 v[60:63], v[8:11], v[28:31], v[60:63]
  s_add_u32 s10, s10, s84
  s_waitcnt vmcnt(4)
  v_perm_b32 v16, v100, v96, s8
  v_perm_b32 v17, v108, v104, s8
  v_perm_b32 v18, v116, v112, s8
  v_perm_b32 v19, v124, v120, s8
  v_perm_b32 v20, v100, v96, s9
  v_perm_b32 v21, v108, v104, s9
  v_perm_b32 v22, v116, v112, s9
  v_perm_b32 v23, v124, v120, s9
  v_perm_b32 v24, v101, v97, s8
  v_perm_b32 v25, v109, v105, s8
  v_perm_b32 v26, v117, v113, s8
  v_perm_b32 v27, v125, v121, s8
  v_perm_b32 v28, v101, v97, s9
  v_perm_b32 v29, v109, v105, s9
  v_perm_b32 v30, v117, v113, s9
  v_perm_b32 v31, v125, v121, s9
  s_waitcnt lgkmcnt(0)
  ds_read_b128 v[8:11], v5 offset:2048
  v_mfma_f32_16x16x32_bf16 v[32:35], v[12:15], v[16:19], v[32:35]
  v_mfma_f32_16x16x32_bf16 v[36:39], v[12:15], v[20:23], v[36:39]
  v_perm_b32 v16, v102, v98, s8
  v_perm_b32 v17, v110, v106, s8
  v_perm_b32 v18, v118, v114, s8
  v_perm_b32 v19, v126, v122, s8
  v_perm_b32 v20, v102, v98, s9
  v_perm_b32 v21, v110, v106, s9
  v_perm_b32 v22, v118, v114, s9
  v_perm_b32 v23, v126, v122, s9
  v_mfma_f32_16x16x32_bf16 v[40:43], v[12:15], v[24:27], v[40:43]
  v_mfma_f32_16x16x32_bf16 v[44:47], v[12:15], v[28:31], v[44:47]
  v_perm_b32 v24, v103, v99, s8
  v_perm_b32 v25, v111, v107, s8
  v_perm_b32 v26, v119, v115, s8
  v_perm_b32 v27, v127, v123, s8
  v_perm_b32 v28, v103, v99, s9
  v_perm_b32 v29, v111, v107, s9
  v_perm_b32 v30, v119, v115, s9
  v_perm_b32 v31, v127, v123, s9
  v_mfma_f32_16x16x32_bf16 v[48:51], v[12:15], v[16:19], v[48:51]
  v_mfma_f32_16x16x32_bf16 v[52:55], v[12:15], v[20:23], v[52:55]
  v_mfma_f32_16x16x32_bf16 v[56:59], v[12:15], v[24:27], v[56:59]
  v_mfma_f32_16x16x32_bf16 v[60:63], v[12:15], v[28:31], v[60:63]
  s_waitcnt vmcnt(0)
  v_perm_b32 v16, v132, v128, s8
  v_perm_b32 v17, v140, v136, s8
  v_perm_b32 v18, v148, v144, s8
  v_perm_b32 v19, v156, v152, s8
  v_perm_b32 v20, v132, v128, s9
  v_perm_b32 v21, v140, v136, s9
  v_perm_b32 v22, v148, v144, s9
  v_perm_b32 v23, v156, v152, s9
  v_perm_b32 v24, v133, v129, s8
  v_perm_b32 v25, v141, v137, s8
  v_perm_b32 v26, v149, v145, s8
  v_perm_b32 v27, v157, v153, s8
  v_perm_b32 v28, v133, v129, s9
  v_perm_b32 v29, v141, v137, s9
  v_perm_b32 v30, v149, v145, s9
  v_perm_b32 v31, v157, v153, s9
  s_waitcnt lgkmcnt(0)
  v_mfma_f32_16x16x32_bf16 v[32:35], v[8:11], v[16:19], v[32:35]
  v_mfma_f32_16x16x32_bf16 v[36:39], v[8:11], v[20:23], v[36:39]
  v_perm_b32 v16, v134, v130, s8
  v_perm_b32 v17, v142, v138, s8
  v_perm_b32 v18, v150, v146, s8
  v_perm_b32 v19, v158, v154, s8
  v_perm_b32 v20, v134, v130, s9
  v_perm_b32 v21, v142, v138, s9
  v_perm_b32 v22, v150, v146, s9
  v_perm_b32 v23, v158, v154, s9
  v_mfma_f32_16x16x32_bf16 v[40:43], v[8:11], v[24:27], v[40:43]
  v_mfma_f32_16x16x32_bf16 v[44:47], v[8:11], v[28:31], v[44:47]
  v_perm_b32 v24, v135, v131, s8
  v_perm_b32 v25, v143, v139, s8
  v_perm_b32 v26, v151, v147, s8
  v_perm_b32 v27, v159, v155, s8
  v_perm_b32 v28, v135, v131, s9
  v_perm_b32 v29, v143, v139, s9
  v_perm_b32 v30, v151, v147, s9
  v_perm_b32 v31, v159, v155, s9
  v_mfma_f32_16x16x32_bf16 v[48:51], v[8:11], v[16:19], v[48:51]
  v_mfma_f32_16x16x32_bf16 v[52:55], v[8:11], v[20:23], v[52:55]
  v_mfma_f32_16x16x32_bf16 v[56:59], v[8:11], v[24:27], v[56:59]
  v_mfma_f32_16x16x32_bf16 v[60:63], v[8:11], v[28:31], v[60:63]
  s_branch L_vdone
L_drain15:
  s_waitcnt vmcnt(4)
  v_perm_b32 v16, v68, v64, s8
  v_perm_b32 v17, v76, v72, s8
  v_perm_b32 v18, v84, v80, s8
  v_perm_b32 v19, v92, v88, s8
  v_perm_b32 v20, v68, v64, s9
  v_perm_b32 v21, v76, v72, s9
  v_perm_b32 v22, v84, v80, s9
  v_perm_b32 v23, v92, v88, s9
  v_perm_b32 v24, v69, v65, s8
  v_perm_b32 v25, v77, v73, s8
  v_perm_b32 v26, v85, v81, s8
  v_perm_b32 v27, v93, v89, s8
  v_perm_b32 v28, v69, v65, s9
  v_perm_b32 v29, v77, v73, s9
  v_perm_b32 v30, v85, v81, s9
  v_perm_b32 v31, v93, v89, s9
  s_waitcnt lgkmcnt(0)
  ds_read_b128 v[12:15], v5 offset:1920
  v_mfma_f32_16x16x32_bf16 v[32:35], v[8:11], v[16:19], v[32:35]
  v_mfma_f32_16x16x32_bf16 v[36:39], v[8:11], v[20:23], v[36:39]
  v_perm_b32 v16, v70, v66, s8
  v_perm_b32 v17, v78, v74, s8
  v_perm_b32 v18, v86, v82, s8
  v_perm_b32 v19, v94, v90, s8
  v_perm_b32 v20, v70, v66, s9
  v_perm_b32 v21, v78, v74, s9
  v_perm_b32 v22, v86, v82, s9
  v_perm_b32 v23, v94, v90, s9
  v_mfma_f32_16x16x32_bf16 v[40:43], v[8:11], v[24:27], v[40:43]
  v_mfma_f32_16x16x32_bf16 v[44:47], v[8:11], v[28:31], v[44:47]
  v_perm_b32 v24, v71, v67, s8
  v_perm_b32 v25, v79, v75, s8
  v_perm_b32 v26, v87, v83, s8
  v_perm_b32 v27, v95, v91, s8
  v_perm_b32 v28, v71, v67, s9
  v_perm_b32 v29, v79, v75, s9
  v_perm_b32 v30, v87, v83, s9
  v_perm_b32 v31, v95, v91, s9
  v_mfma_f32_16x16x32_bf16 v[48:51], v[8:11], v[16:19], v[48:51]
  v_mfma_f32_16x16x32_bf16 v[52:55], v[8:11], v[20:23], v[52:55]
  v_mfma_f32_16x16x32_bf16 v[56:59], v[8:11], v[24:27], v[56:59]
  v_mfma_f32_16x16x32_bf16 v[60:63], v[8:11], v[28:31], v[60:63]
  s_waitcnt vmcnt(0)
  v_perm_b32 v16, v100, v96, s8
  v_perm_b32 v17, v108, v104, s8
  v_perm_b32 v18, v116, v112, s8
  v_perm_b32 v19, v124, v120, s8
  v_perm_b32 v20, v100, v96, s9
  v_perm_b32 v21, v108, v104, s9
  v_perm_b32 v22, v116, v112, s9
  v_perm_b32 v23, v124, v120, s9
  v_perm_b32 v24, v101, v97, s8
  v_perm_b32 v25, v109, v105, s8
  v_perm_b32 v26, v117, v113, s8
  v_perm_b32 v27, v125, v121, s8
  v_perm_b32 v28, v101, v97, s9
  v_perm_b32 v29, v109, v105, s9
  v_perm_b32 v30, v117, v113, s9
  v_perm_b32 v31, v125, v121, s9
  s_waitcnt lgkmcnt(0)
  ds_read_b128 v[8:11], v5 offset:2048
  v_mfma_f32_16x16x32_bf16 v[32:35], v[12:15], v[16:19], v[32:35]
  v_mfma_f32_16x16x32_bf16 v[36:39], v[12:15], v[20:23], v[36:39]
  v_perm_b32 v16, v102, v98, s8
  v_perm_b32 v17, v110, v106, s8
  v_perm_b32 v18, v118, v114, s8
  v_perm_b32 v19, v126, v122, s8
  v_perm_b32 v20, v102, v98, s9
  v_perm_b32 v21, v110, v106, s9
  v_perm_b32 v22, v118, v114, s9
  v_perm_b32 v23, v126, v122, s9
  v_mfma_f32_16x16x32_bf16 v[40:43], v[12:15], v[24:27], v[40:43]
  v_mfma_f32_16x16x32_bf16 v[44:47], v[12:15], v[28:31], v[44:47]
  v_perm_b32 v24, v103, v99, s8
  v_perm_b32 v25, v111, v107, s8
  v_perm_b32 v26, v119, v115, s8
  v_perm_b32 v27, v127, v123, s8
  v_perm_b32 v28, v103, v99, s9
  v_perm_b32 v29, v111, v107, s9
  v_perm_b32 v30, v119, v115, s9
  v_perm_b32 v31, v127, v123, s9
  v_mfma_f32_16x16x32_bf16 v[48:51], v[12:15], v[16:19], v[48:51]
  v_mfma_f32_16x16x32_bf16 v[52:55], v[12:15], v[20:23], v[52:55]
  v_mfma_f32_16x16x32_bf16 v[56:59], v[12:15], v[24:27], v[56:59]
  v_mfma_f32_16x16x32_bf16 v[60:63], v[12:15], v[28:31], v[60:63]
L_vdone:
  s_nop 7
  v_lshlrev_b32 v5, 5, v4
  s_add_u32 s15, s15, 1024
  v_add_u32 v5, s15, v5
  s_waitcnt lgkmcnt(0)
  s_mov_b64 exec, 0xffff
  ds_write2_b32 v5, v32, v33 offset0:0 offset1:128
  ds_write2_b32 v5, v36, v37 offset0:1 offset1:129
  ds_write2_b32 v5, v40, v41 offset0:2 offset1:130
  ds_write2_b32 v5, v44, v45 offset0:3 offset1:131
  ds_write2_b32 v5, v48, v49 offset0:4 offset1:132
  ds_write2_b32 v5, v52, v53 offset0:5 offset1:133
  ds_write2_b32 v5, v56, v57 offset0:6 offset1:134
  ds_write2_b32 v5, v60, v61 offset0:7 offset1:135
  s_mov_b64 exec, -1
  s_waitcnt lgkmcnt(0)
  s_barrier
  s_mov_b64 exec, -1
  s_bfe_u32 s13, s2, 0x10003
  s_cmp_lt_u32 s5, 72
  s_cselect_b32 s13, s13, 2
  s_cmp_eq_u32 s13, s6
  s_cbranch_scc0 L_end
  s_setprio 3
  s_add_u32 s94, s3, 4
  s_mov_b32 s60, s36
  s_mov_b32 s61, s37
  s_mov_b32 s62, 9216
  s_mov_b32 s63, 0x20000
  s_mul_i32 s13, s94, 13824
  s_add_u32 s14, s13, 13312
  s_add_u32 s13, s13, 11008
  v_lshlrev_b32 v6, 3, v4
  s_mul_i32 s8, s94, 2304
  s_add_u32 s8, s8, 2228224
  v_add_u32 v26, s8, v6
  s_mul_i32 s8, s94, 1184
  s_add_u32 s8, s8, 147456
  v_lshlrev_b32 v27, 2, v4
  v_add_u32 v27, s8, v27
  s_mov_b64 s[66:67], s[42:43]
  s_mov_b64 s[68:69], s[42:43]
  s_mov_b64 s[70:71], s[42:43]
  s_mov_b64 s[72:73], s[42:43]
  s_mov_b32 s74, s42
  s_mov_b32 s75, 0
  s_mov_b64 s[76:77], s[42:43]
  s_mov_b64 s[78:79], s[42:43]
  s_mov_b64 s[80:81], s[42:43]
  s_mov_b64 s[82:83], s[42:43]
  s_mov_b32 s84, s42
  s_mov_b32 s85, 0
  s_mov_b32 s92, 300000
L_g_90:
  s_mov_b64 exec, s[66:67]
  s_cbranch_execz L_gs_92
  buffer_load_dwordx2 v[76:77], v6, s[52:55], s13 offen offset:0 sc1
L_gs_92:
  s_mov_b64 exec, s[68:69]
  s_cbranch_execz L_gs_93
  buffer_load_dwordx2 v[78:79], v6, s[52:55], s13 offen offset:512 sc1
L_gs_93:
  s_mov_b64 exec, s[70:71]
  s_cbranch_execz L_gs_94
  buffer_load_dwordx2 v[80:81], v6, s[52:55], s13 offen offset:1024 sc1
L_gs_94:
  s_mov_b64 exec, s[72:73]
  s_cbranch_execz L_gs_95
  buffer_load_dwordx2 v[82:83], v6, s[52:55], s13 offen offset:1536 sc1
L_gs_95:
  s_mov_b64 exec, s[74:75]
  s_cbranch_execz L_gs_96
  buffer_load_dwordx2 v[84:85], v6, s[52:55], s13 offen offset:2048 sc1
L_gs_96:
  s_mov_b64 exec, s[76:77]
  s_cbranch_execz L_gs_97
  buffer_load_dwordx2 v[86:87], v6, s[52:55], s14 offen offset:0 sc1
L_gs_97:
  s_mov_b64 exec, s[78:79]
  s_cbranch_execz L_gs_98
  buffer_load_dwordx2 v[88:89], v6, s[52:55], s14 offen offset:512 sc1
L_gs_98:
  s_mov_b64 exec, s[80:81]
  s_cbranch_execz L_gs_99
  buffer_load_dwordx2 v[90:91], v6, s[52:55], s14 offen offset:1024 sc1
L_gs_99:
  s_mov_b64 exec, s[82:83]
  s_cbranch_execz L_gs_100
  buffer_load_dwordx2 v[92:93], v6, s[52:55], s14 offen offset:1536 sc1
L_gs_100:
  s_mov_b64 exec, s[84:85]
  s_cbranch_execz L_gs_101
  buffer_load_dwordx2 v[94:95], v6, s[52:55], s14 offen offset:2048 sc1
L_gs_101:
  s_mov_b64 exec, s[42:43]
  s_waitcnt vmcnt(0)
  v_cmp_ne_u32 vcc, v3, v77
  s_nop 1
  s_and_b64 s[66:67], s[66:67], vcc
  v_cmp_ne_u32 vcc, v3, v79
  s_nop 1
  s_and_b64 s[68:69], s[68:69], vcc
  v_cmp_ne_u32 vcc, v3, v81
  s_nop 1
  s_and_b64 s[70:71], s[70:71], vcc
  v_cmp_ne_u32 vcc, v3, v83
  s_nop 1
  s_and_b64 s[72:73], s[72:73], vcc
  v_cmp_ne_u32 vcc, v3, v85
  s_nop 1
  s_and_b64 s[74:75], s[74:75], vcc
  v_cmp_ne_u32 vcc, v3, v87
  s_nop 1
  s_and_b64 s[76:77], s[76:77], vcc
  v_cmp_ne_u32 vcc, v3, v89
  s_nop 1
  s_and_b64 s[78:79], s[78:79], vcc
  v_cmp_ne_u32 vcc, v3, v91
  s_nop 1
  s_and_b64 s[80:81], s[80:81], vcc
  v_cmp_ne_u32 vcc, v3, v93
  s_nop 1
  s_and_b64 s[82:83], s[82:83], vcc
  v_cmp_ne_u32 vcc, v3, v95
  s_nop 1
  s_and_b64 s[84:85], s[84:85], vcc
  s_mov_b64 s[90:91], 0
  s_or_b64 s[90:91], s[90:91], s[66:67]
  s_or_b64 s[90:91], s[90:91], s[68:69]
  s_or_b64 s[90:91], s[90:91], s[70:71]
  s_or_b64 s[90:91], s[90:91], s[72:73]
  s_or_b64 s[90:91], s[90:91], s[74:75]
  s_or_b64 s[90:91], s[90:91], s[76:77]
  s_or_b64 s[90:91], s[90:91], s[78:79]
  s_or_b64 s[90:91], s[90:91], s[80:81]
  s_or_b64 s[90:91], s[90:91], s[82:83]
  s_or_b64 s[90:91], s[90:91], s[84:85]
  s_cbranch_scc0 L_gd_91
  s_sub_u32 s92, s92, 1
  s_cbranch_scc1 L_gd_91
  s_sleep 4
  s_branch L_g_90
L_gd_91:
  s_mov_b64 exec, s[42:43]
  v_lshlrev_b32 v40, 16, v76
  v_and_b32 v41, 0xffff0000, v76
  v_lshlrev_b32 v42, 16, v78
  v_and_b32 v43, 0xffff0000, v78
  v_lshlrev_b32 v44, 16, v80
  v_and_b32 v45, 0xffff0000, v80
  v_lshlrev_b32 v46, 16, v82
  v_and_b32 v47, 0xffff0000, v82
  v_lshlrev_b32 v48, 16, v84
  v_and_b32 v49, 0xffff0000, v84
  v_lshlrev_b32 v18, 16, v86
  v_and_b32 v19, 0xffff0000, v86
  v_add_f32 v18, 1.0, v18
  v_add_f32 v19, 1.0, v19
  v_cvt_pk_bf16_f32 v22, v18, v19
  v_lshlrev_b32 v58, 16, v22
  v_and_b32 v59, 0xffff0000, v22
  v_lshlrev_b32 v18, 16, v88
  v_and_b32 v19, 0xffff0000, v88
  v_add_f32 v18, 1.0, v18
  v_add_f32 v19, 1.0, v19
  v_cvt_pk_bf16_f32 v22, v18, v19
  v_lshlrev_b32 v60, 16, v22
  v_and_b32 v61, 0xffff0000, v22
  v_lshlrev_b32 v18, 16, v90
  v_and_b32 v19, 0xffff0000, v90
  v_add_f32 v18, 1.0, v18
  v_add_f32 v19, 1.0, v19
  v_cvt_pk_bf16_f32 v22, v18, v19
  v_lshlrev_b32 v62, 16, v22
  v_and_b32 v63, 0xffff0000, v22
  v_lshlrev_b32 v18, 16, v92
  v_and_b32 v19, 0xffff0000, v92
  v_add_f32 v18, 1.0, v18
  v_add_f32 v19, 1.0, v19
  v_cvt_pk_bf16_f32 v22, v18, v19
  v_lshlrev_b32 v64, 16, v22
  v_and_b32 v65, 0xffff0000, v22
  v_lshlrev_b32 v18, 16, v94
  v_and_b32 v19, 0xffff0000, v94
  v_add_f32 v18, 1.0, v18
  v_add_f32 v19, 1.0, v19
  v_cvt_pk_bf16_f32 v22, v18, v19
  v_lshlrev_b32 v66, 16, v22
  v_and_b32 v67, 0xffff0000, v22
  v_mov_b32 v84, 0
  s_barrier
  s_barrier
  s_branch L_mln
L_ctrl:
  s_setprio 3
  s_sub_u32 s3, s3, 4
  s_add_u32 s9, s5, 56
  s_cmp_eq_u32 s6, 0
  s_cselect_b32 s9, s9, s5
  s_cmp_lt_u32 s5, 72
  s_cselect_b32 s7, s5, s9
  s_cselect_b32 s9, s13, 2
  s_cmp_eq_u32 s9, s6
  s_cselect_b32 s98, s5, -1
  s_cselect_b32 s7, 1000, s7
  s_cmp_lt_u32 s7, 144
  s_cselect_b32 s95, s7, -1
  s_sub_u32 s8, 181, s7
  s_cmp_lt_u32 s8, 54
  s_cselect_b32 s93, s8, -1
  s_cmp_lt_u32 s3, 3
  s_cselect_b32 s93, s93, -1
  v_lshrrev_b32 v8, 3, v4
  v_and_b32 v9, 7, v4
  v_lshlrev_b32 v9, 4, v9
  v_mov_b32 v5, 0
  s_cmp_lg_u32 s93, -1
  s_waitcnt lgkmcnt(0)
  s_cbranch_scc0 L_notP1
  s_mov_b32 s48, s34
  s_mov_b32 s49, s35
  s_mov_b32 s50, 3981312
  s_mov_b32 s51, 0x20000
  v_mul_u32_u24 v13, 6912, v8
  v_add_u32 v13, v13, v9
  s_mul_i32 s8, s3, 1327104
  s_lshl_b32 s9, s93, 7
  s_add_u32 s8, s8, s9
  s_mul_i32 s9, s3, 24576
  s_mov_b32 s44, s32
  s_mov_b32 s45, s33
  s_mov_b32 s46, 9216
  s_mov_b32 s47, 0x20000
  v_and_b32 v14, 7, v4
  v_mul_u32_u24 v14, 1152, v14
  v_bfe_u32 v15, v4, 3, 1
  v_mul_u32_u24 v15, 192, v15
  v_add_u32 v14, v14, v15
  v_lshrrev_b32 v15, 4, v4
  v_lshlrev_b32 v15, 4, v15
  v_add_u32 v14, v14, v15
  s_mul_i32 s11, s3, 384
  buffer_load_dwordx4 v[112:115], v14, s[44:47], s11 offen offset:0
  buffer_load_dwordx4 v[116:119], v14, s[44:47], s11 offen offset:64
  buffer_load_dwordx4 v[120:123], v14, s[44:47], s11 offen offset:128
  s_mov_b32 s52, s40
  s_mov_b32 s53, s41
  s_mov_b32 s54, 16777216
  s_mov_b32 s55, 0x20000
  buffer_load_dword v3, v5, s[52:55], 0 offen sc1
  s_add_u32 s10, s9, 6144
L_dma_102:
  s_mov_b32 m0, s9
  s_add_u32 s9, s9, 1024
  buffer_load_dwordx4 v13, s[48:51], s8 offen nt lds
  s_add_u32 s8, s8, 55296
  s_cmp_lt_u32 s9, s10
  s_cbranch_scc1 L_dma_102
  v_mov_b32 v6, 160320
  ds_write_b32 v6, v5
  v_lshrrev_b32 v10, 4, v4
  v_lshlrev_b32 v10, 3, v10
  v_bfe_u32 v11, v4, 2, 2
  v_add_u32 v11, v10, v11
  v_lshlrev_b32 v10, 7, v11
  v_and_b32 v12, 3, v4
  v_lshlrev_b32 v12, 3, v12
  v_add_u32 v10, v10, v12
  v_lshrrev_b32 v24, 5, v4
  v_and_b32 v25, 31, v4
  v_mov_b32 v44, 3216550459
  v_mov_b32 v45, 3216550459
  v_mov_b32 v46, 2997186656
  v_mov_b32 v47, 2997186656
  v_mov_b32 v48, 1060205080
  v_mov_b32 v49, 1060205080
  v_mov_b32 v50, 1.0
  v_mov_b32 v51, 1.0
  s_mov_b32 s11, 1124007936
  s_waitcnt vmcnt(6)
  v_add_u32 v3, 2654435769, v3
  s_mov_b32 m0, s9
  s_add_u32 s9, s9, 1024
  buffer_load_dwordx4 v13, s[48:51], s8 offen nt lds
  s_add_u32 s8, s8, 55296
  s_mov_b32 m0, s9
  s_add_u32 s9, s9, 1024
  buffer_load_dwordx4 v13, s[48:51], s8 offen nt lds
  s_add_u32 s8, s8, 55296
  s_mov_b32 m0, s9
  s_add_u32 s9, s9, 1024
  buffer_load_dwordx4 v13, s[48:51], s8 offen nt lds
  s_add_u32 s8, s8, 55296
  v_lshlrev_b32 v52, 16, v112
  v_and_b32 v53, 0xffff0000, v112
  v_lshlrev_b32 v64, 16, v113
  v_and_b32 v65, 0xffff0000, v113
  v_pk_mul_f32 v[54:55], v[52:53], v[44:45]
  v_pk_mul_f32 v[66:67], v[64:65], v[44:45]
  v_pk_fma_f32 v[56:57], v[52:53], v[44:45], v[54:55] neg_lo:[0,0,1] neg_hi:[0,0,1]
  v_pk_fma_f32 v[68:69], v[64:65], v[44:45], v[66:67] neg_lo:[0,0,1] neg_hi:[0,0,1]
  v_min_f32 v54, s11, v54
  v_min_f32 v55, s11, v55
  v_min_f32 v66, s11, v66
  v_min_f32 v67, s11, v67
  v_pk_fma_f32 v[56:57], v[52:53], v[46:47], v[56:57]
  v_pk_fma_f32 v[68:69], v[64:65], v[46:47], v[68:69]
  v_exp_f32 v58, v54
  v_exp_f32 v59, v55
  v_exp_f32 v70, v66
  v_exp_f32 v71, v67
  v_pk_mul_f32 v[56:57], v[56:57], v[48:49]
  v_pk_mul_f32 v[68:69], v[68:69], v[48:49]
  v_pk_fma_f32 v[58:59], v[58:59], v[56:57], v[58:59]
  v_pk_fma_f32 v[70:71], v[70:71], v[68:69], v[70:71]
  v_pk_add_f32 v[58:59], v[58:59], v[50:51]
  v_pk_add_f32 v[70:71], v[70:71], v[50:51]
  v_rcp_f32 v54, v58
  v_rcp_f32 v55, v59
  v_rcp_f32 v66, v70
  v_rcp_f32 v67, v71
  v_pk_mul_f32 v[60:61], v[52:53], v[54:55]
  v_pk_mul_f32 v[72:73], v[64:65], v[66:67]
  v_pk_fma_f32 v[56:57], v[60:61], v[58:59], v[52:53] neg_lo:[1,0,0] neg_hi:[1,0,0]
  v_pk_fma_f32 v[68:69], v[72:73], v[70:71], v[64:65] neg_lo:[1,0,0] neg_hi:[1,0,0]
  v_pk_fma_f32 v[60:61], v[56:57], v[54:55], v[60:61]
  v_pk_fma_f32 v[72:73], v[68:69], v[66:67], v[72:73]
  v_cvt_pk_bf16_f32 v112, v60, v61
  v_cvt_pk_bf16_f32 v113, v72, v73
  s_mov_b32 m0, s9
  s_add_u32 s9, s9, 1024
  buffer_load_dwordx4 v13, s[48:51], s8 offen nt lds
  s_add_u32 s8, s8, 55296
  s_mov_b32 m0, s9
  s_add_u32 s9, s9, 1024
  buffer_load_dwordx4 v13, s[48:51], s8 offen nt lds
  s_add_u32 s8, s8, 55296
  s_mov_b32 m0, s9
  s_add_u32 s9, s9, 1024
  buffer_load_dwordx4 v13, s[48:51], s8 offen nt lds
  s_add_u32 s8, s8, 55296
  v_lshlrev_b32 v52, 16, v114
  v_and_b32 v53, 0xffff0000, v114
  v_lshlrev_b32 v64, 16, v115
  v_and_b32 v65, 0xffff0000, v115
  v_pk_mul_f32 v[54:55], v[52:53], v[44:45]
  v_pk_mul_f32 v[66:67], v[64:65], v[44:45]
  v_pk_fma_f32 v[56:57], v[52:53], v[44:45], v[54:55] neg_lo:[0,0,1] neg_hi:[0,0,1]
  v_pk_fma_f32 v[68:69], v[64:65], v[44:45], v[66:67] neg_lo:[0,0,1] neg_hi:[0,0,1]
  v_min_f32 v54, s11, v54
  v_min_f32 v55, s11, v55
  v_min_f32 v66, s11, v66
  v_min_f32 v67, s11, v67
  v_pk_fma_f32 v[56:57], v[52:53], v[46:47], v[56:57]
  v_pk_fma_f32 v[68:69], v[64:65], v[46:47], v[68:69]
  v_exp_f32 v58, v54
  v_exp_f32 v59, v55
  v_exp_f32 v70, v66
  v_exp_f32 v71, v67
  v_pk_mul_f32 v[56:57], v[56:57], v[48:49]
  v_pk_mul_f32 v[68:69], v[68:69], v[48:49]
  v_pk_fma_f32 v[58:59], v[58:59], v[56:57], v[58:59]
  v_pk_fma_f32 v[70:71], v[70:71], v[68:69], v[70:71]
  v_pk_add_f32 v[58:59], v[58:59], v[50:51]
  v_pk_add_f32 v[70:71], v[70:71], v[50:51]
  v_rcp_f32 v54, v58
  v_rcp_f32 v55, v59
  v_rcp_f32 v66, v70
  v_rcp_f32 v67, v71
  v_pk_mul_f32 v[60:61], v[52:53], v[54:55]
  v_pk_mul_f32 v[72:73], v[64:65], v[66:67]
  v_pk_fma_f32 v[56:57], v[60:61], v[58:59], v[52:53] neg_lo:[1,0,0] neg_hi:[1,0,0]
  v_pk_fma_f32 v[68:69], v[72:73], v[70:71], v[64:65] neg_lo:[1,0,0] neg_hi:[1,0,0]
  v_pk_fma_f32 v[60:61], v[56:57], v[54:55], v[60:61]
  v_pk_fma_f32 v[72:73], v[68:69], v[66:67], v[72:73]
  v_cvt_pk_bf16_f32 v114, v60, v61
  v_cvt_pk_bf16_f32 v115, v72, v73
  s_mov_b32 m0, s9
  s_add_u32 s9, s9, 1024
  buffer_load_dwordx4 v13, s[48:51], s8 offen nt lds
  s_add_u32 s8, s8, 55296
  s_mov_b32 m0, s9
  s_add_u32 s9, s9, 1024
  buffer_load_dwordx4 v13, s[48:51], s8 offen nt lds
  s_add_u32 s8, s8, 55296
  s_mov_b32 m0, s9
  s_add_u32 s9, s9, 1024
  buffer_load_dwordx4 v13, s[48:51], s8 offen nt lds
  s_add_u32 s8, s8, 55296
  v_lshlrev_b32 v52, 16, v116
  v_and_b32 v53, 0xffff0000, v116
  v_lshlrev_b32 v64, 16, v117
  v_and_b32 v65, 0xffff0000, v117
  v_pk_mul_f32 v[54:55], v[52:53], v[44:45]
  v_pk_mul_f32 v[66:67], v[64:65], v[44:45]
  v_pk_fma_f32 v[56:57], v[52:53], v[44:45], v[54:55] neg_lo:[0,0,1] neg_hi:[0,0,1]
  v_pk_fma_f32 v[68:69], v[64:65], v[44:45], v[66:67] neg_lo:[0,0,1] neg_hi:[0,0,1]
  v_min_f32 v54, s11, v54
  v_min_f32 v55, s11, v55
  v_min_f32 v66, s11, v66
  v_min_f32 v67, s11, v67
  v_pk_fma_f32 v[56:57], v[52:53], v[46:47], v[56:57]
  v_pk_fma_f32 v[68:69], v[64:65], v[46:47], v[68:69]
  v_exp_f32 v58, v54
  v_exp_f32 v59, v55
  v_exp_f32 v70, v66
  v_exp_f32 v71, v67
  v_pk_mul_f32 v[56:57], v[56:57], v[48:49]
  v_pk_mul_f32 v[68:69], v[68:69], v[48:49]
  v_pk_fma_f32 v[58:59], v[58:59], v[56:57], v[58:59]
  v_pk_fma_f32 v[70:71], v[70:71], v[68:69], v[70:71]
  v_pk_add_f32 v[58:59], v[58:59], v[50:51]
  v_pk_add_f32 v[70:71], v[70:71], v[50:51]
  v_rcp_f32 v54, v58
  v_rcp_f32 v55, v59
  v_rcp_f32 v66, v70
  v_rcp_f32 v67, v71
  v_pk_mul_f32 v[60:61], v[52:53], v[54:55]
  v_pk_mul_f32 v[72:73], v[64:65], v[66:67]
  v_pk_fma_f32 v[56:57], v[60:61], v[58:59], v[52:53] neg_lo:[1,0,0] neg_hi:[1,0,0]
  v_pk_fma_f32 v[68:69], v[72:73], v[70:71], v[64:65] neg_lo:[1,0,0] neg_hi:[1,0,0]
  v_pk_fma_f32 v[60:61], v[56:57], v[54:55], v[60:61]
  v_pk_fma_f32 v[72:73], v[68:69], v[66:67], v[72:73]
  v_cvt_pk_bf16_f32 v116, v60, v61
  v_cvt_pk_bf16_f32 v117, v72, v73
  s_mov_b32 m0, s9
  s_add_u32 s9, s9, 1024
  buffer_load_dwordx4 v13, s[48:51], s8 offen nt lds
  s_add_u32 s8, s8, 55296
  s_mov_b32 m0, s9
  s_add_u32 s9, s9, 1024
  buffer_load_dwordx4 v13, s[48:51], s8 offen nt lds
  s_add_u32 s8, s8, 55296
  s_mov_b32 m0, s9
  s_add_u32 s9, s9, 1024
  buffer_load_dwordx4 v13, s[48:51], s8 offen nt lds
  s_add_u32 s8, s8, 55296
  v_lshlrev_b32 v52, 16, v118
  v_and_b32 v53, 0xffff0000, v118
  v_lshlrev_b32 v64, 16, v119
  v_and_b32 v65, 0xffff0000, v119
  v_pk_mul_f32 v[54:55], v[52:53], v[44:45]
  v_pk_mul_f32 v[66:67], v[64:65], v[44:45]
  v_pk_fma_f32 v[56:57], v[52:53], v[44:45], v[54:55] neg_lo:[0,0,1] neg_hi:[0,0,1]
  v_pk_fma_f32 v[68:69], v[64:65], v[44:45], v[66:67] neg_lo:[0,0,1] neg_hi:[0,0,1]
  v_min_f32 v54, s11, v54
  v_min_f32 v55, s11, v55
  v_min_f32 v66, s11, v66
  v_min_f32 v67, s11, v67
  v_pk_fma_f32 v[56:57], v[52:53], v[46:47], v[56:57]
  v_pk_fma_f32 v[68:69], v[64:65], v[46:47], v[68:69]
  v_exp_f32 v58, v54
  v_exp_f32 v59, v55
  v_exp_f32 v70, v66
  v_exp_f32 v71, v67
  v_pk_mul_f32 v[56:57], v[56:57], v[48:49]
  v_pk_mul_f32 v[68:69], v[68:69], v[48:49]
  v_pk_fma_f32 v[58:59], v[58:59], v[56:57], v[58:59]
  v_pk_fma_f32 v[70:71], v[70:71], v[68:69], v[70:71]
  v_pk_add_f32 v[58:59], v[58:59], v[50:51]
  v_pk_add_f32 v[70:71], v[70:71], v[50:51]
  v_rcp_f32 v54, v58
  v_rcp_f32 v55, v59
  v_rcp_f32 v66, v70
  v_rcp_f32 v67, v71
  v_pk_mul_f32 v[60:61], v[52:53], v[54:55]
  v_pk_mul_f32 v[72:73], v[64:65], v[66:67]
  v_pk_fma_f32 v[56:57], v[60:61], v[58:59], v[52:53] neg_lo:[1,0,0] neg_hi:[1,0,0]
  v_pk_fma_f32 v[68:69], v[72:73], v[70:71], v[64:65] neg_lo:[1,0,0] neg_hi:[1,0,0]
  v_pk_fma_f32 v[60:61], v[56:57], v[54:55], v[60:61]
  v_pk_fma_f32 v[72:73], v[68:69], v[66:67], v[72:73]
  v_cvt_pk_bf16_f32 v118, v60, v61
  v_cvt_pk_bf16_f32 v119, v72, v73
  s_mov_b32 m0, s9
  s_add_u32 s9, s9, 1024
  buffer_load_dwordx4 v13, s[48:51], s8 offen nt lds
  s_add_u32 s8, s8, 55296
  s_mov_b32 m0, s9
  s_add_u32 s9, s9, 1024
  buffer_load_dwordx4 v13, s[48:51], s8 offen nt lds
  s_add_u32 s8, s8, 55296
  s_mov_b32 m0, s9
  s_add_u32 s9, s9, 1024
  buffer_load_dwordx4 v13, s[48:51], s8 offen nt lds
  s_add_u32 s8, s8, 55296
  v_lshlrev_b32 v52, 16, v120
  v_and_b32 v53, 0xffff0000, v120
  v_lshlrev_b32 v64, 16, v121
  v_and_b32 v65, 0xffff0000, v121
  v_pk_mul_f32 v[54:55], v[52:53], v[44:45]
  v_pk_mul_f32 v[66:67], v[64:65], v[44:45]
  v_pk_fma_f32 v[56:57], v[52:53], v[44:45], v[54:55] neg_lo:[0,0,1] neg_hi:[0,0,1]
  v_pk_fma_f32 v[68:69], v[64:65], v[44:45], v[66:67] neg_lo:[0,0,1] neg_hi:[0,0,1]
  v_min_f32 v54, s11, v54
  v_min_f32 v55, s11, v55
  v_min_f32 v66, s11, v66
  v_min_f32 v67, s11, v67
  v_pk_fma_f32 v[56:57], v[52:53], v[46:47], v[56:57]
  v_pk_fma_f32 v[68:69], v[64:65], v[46:47], v[68:69]
  v_exp_f32 v58, v54
  v_exp_f32 v59, v55
  v_exp_f32 v70, v66
  v_exp_f32 v71, v67
  v_pk_mul_f32 v[56:57], v[56:57], v[48:49]
  v_pk_mul_f32 v[68:69], v[68:69], v[48:49]
  v_pk_fma_f32 v[58:59], v[58:59], v[56:57], v[58:59]
  v_pk_fma_f32 v[70:71], v[70:71], v[68:69], v[70:71]
  v_pk_add_f32 v[58:59], v[58:59], v[50:51]
  v_pk_add_f32 v[70:71], v[70:71], v[50:51]
  v_rcp_f32 v54, v58
  v_rcp_f32 v55, v59
  v_rcp_f32 v66, v70
  v_rcp_f32 v67, v71
  v_pk_mul_f32 v[60:61], v[52:53], v[54:55]
  v_pk_mul_f32 v[72:73], v[64:65], v[66:67]
  v_pk_fma_f32 v[56:57], v[60:61], v[58:59], v[52:53] neg_lo:[1,0,0] neg_hi:[1,0,0]
  v_pk_fma_f32 v[68:69], v[72:73], v[70:71], v[64:65] neg_lo:[1,0,0] neg_hi:[1,0,0]
  v_pk_fma_f32 v[60:61], v[56:57], v[54:55], v[60:61]
  v_pk_fma_f32 v[72:73], v[68:69], v[66:67], v[72:73]
  v_cvt_pk_bf16_f32 v120, v60, v61
  v_cvt_pk_bf16_f32 v121, v72, v73
  s_mov_b32 m0, s9
  s_add_u32 s9, s9, 1024
  buffer_load_dwordx4 v13, s[48:51], s8 offen nt lds
  s_add_u32 s8, s8, 55296
  s_mov_b32 m0, s9
  s_add_u32 s9, s9, 1024
  buffer_load_dwordx4 v13, s[48:51], s8 offen nt lds
  s_add_u32 s8, s8, 55296
  s_mov_b32 m0, s9
  s_add_u32 s9, s9, 1024
  buffer_load_dwordx4 v13, s[48:51], s8 offen nt lds
  s_add_u32 s8, s8, 55296
  s_waitcnt lgkmcnt(0)
  s_barrier
  v_lshlrev_b32 v52, 16, v122
  v_and_b32 v53, 0xffff0000, v122
  v_lshlrev_b32 v64, 16, v123
  v_and_b32 v65, 0xffff0000, v123
  v_pk_mul_f32 v[54:55], v[52:53], v[44:45]
  v_pk_mul_f32 v[66:67], v[64:65], v[44:45]
  v_pk_fma_f32 v[56:57], v[52:53], v[44:45], v[54:55] neg_lo:[0,0,1] neg_hi:[0,0,1]
  v_pk_fma_f32 v[68:69], v[64:65], v[44:45], v[66:67] neg_lo:[0,0,1] neg_hi:[0,0,1]
  v_min_f32 v54, s11, v54
  v_min_f32 v55, s11, v55
  v_min_f32 v66, s11, v66
  v_min_f32 v67, s11, v67
  v_pk_fma_f32 v[56:57], v[52:53], v[46:47], v[56:57]
  v_pk_fma_f32 v[68:69], v[64:65], v[46:47], v[68:69]
  v_exp_f32 v58, v54
  v_exp_f32 v59, v55
  v_exp_f32 v70, v66
  v_exp_f32 v71, v67
  v_pk_mul_f32 v[56:57], v[56:57], v[48:49]
  v_pk_mul_f32 v[68:69], v[68:69], v[48:49]
  v_pk_fma_f32 v[58:59], v[58:59], v[56:57], v[58:59]
  v_pk_fma_f32 v[70:71], v[70:71], v[68:69], v[70:71]
  v_pk_add_f32 v[58:59], v[58:59], v[50:51]
  v_pk_add_f32 v[70:71], v[70:71], v[50:51]
  v_rcp_f32 v54, v58
  v_rcp_f32 v55, v59
  v_rcp_f32 v66, v70
  v_rcp_f32 v67, v71
  v_pk_mul_f32 v[60:61], v[52:53], v[54:55]
  v_pk_mul_f32 v[72:73], v[64:65], v[66:67]
  v_pk_fma_f32 v[56:57], v[60:61], v[58:59], v[52:53] neg_lo:[1,0,0] neg_hi:[1,0,0]
  v_pk_fma_f32 v[68:69], v[72:73], v[70:71], v[64:65] neg_lo:[1,0,0] neg_hi:[1,0,0]
  v_pk_fma_f32 v[60:61], v[56:57], v[54:55], v[60:61]
  v_pk_fma_f32 v[72:73], v[68:69], v[66:67], v[72:73]
  v_cvt_pk_bf16_f32 v122, v60, v61
  v_cvt_pk_bf16_f32 v123, v72, v73
  s_mul_i32 s8, s3, 24576
  v_add_u32 v14, s8, v10
  s_waitcnt vmcnt(16)
  ds_read_b64_tr_b16 v[80:81], v14 offset:0
  ds_read_b64_tr_b16 v[82:83], v14 offset:512
  ds_read_b64_tr_b16 v[84:85], v14 offset:32
  ds_read_b64_tr_b16 v[86:87], v14 offset:544
  ds_read_b64_tr_b16 v[88:89], v14 offset:64
  ds_read_b64_tr_b16 v[90:91], v14 offset:576
  ds_read_b64_tr_b16 v[92:93], v14 offset:96
  ds_read_b64_tr_b16 v[94:95], v14 offset:608
  ds_read_b64_tr_b16 v[96:97], v14 offset:4096
  ds_read_b64_tr_b16 v[98:99], v14 offset:4608
  ds_read_b64_tr_b16 v[100:101], v14 offset:4128
  ds_read_b64_tr_b16 v[102:103], v14 offset:4640
  ds_read_b64_tr_b16 v[104:105], v14 offset:4160
  ds_read_b64_tr_b16 v[106:107], v14 offset:4672
  ds_read_b64_tr_b16 v[108:109], v14 offset:4192
  ds_read_b64_tr_b16 v[110:111], v14 offset:4704
  s_waitcnt lgkmcnt(12)
  v_mfma_f32_16x16x32_bf16 v[32:35], v[112:115], v[80:83], 0
  v_mfma_f32_16x16x32_bf16 v[36:39], v[112:115], v[84:87], 0
  s_waitcnt lgkmcnt(8)
  v_mfma_f32_16x16x32_bf16 v[40:43], v[112:115], v[88:91], 0
  v_mfma_f32_16x16x32_bf16 v[44:47], v[112:115], v[92:95], 0
  s_waitcnt lgkmcnt(4)
  v_mfma_f32_16x16x32_bf16 v[32:35], v[116:119], v[96:99], v[32:35]
  v_mfma_f32_16x16x32_bf16 v[36:39], v[116:119], v[100:103], v[36:39]
  s_waitcnt lgkmcnt(0)
  v_mfma_f32_16x16x32_bf16 v[40:43], v[116:119], v[104:107], v[40:43]
  v_mfma_f32_16x16x32_bf16 v[44:47], v[116:119], v[108:111], v[44:47]
  s_waitcnt vmcnt(8)
  ds_read_b64_tr_b16 v[80:81], v14 offset:8192
  ds_read_b64_tr_b16 v[82:83], v14 offset:8704
  ds_read_b64_tr_b16 v[84:85], v14 offset:8224
  ds_read_b64_tr_b16 v[86:87], v14 offset:8736
  ds_read_b64_tr_b16 v[88:89], v14 offset:8256
  ds_read_b64_tr_b16 v[90:91], v14 offset:8768
  ds_read_b64_tr_b16 v[92:93], v14 offset:8288
  ds_read_b64_tr_b16 v[94:95], v14 offset:8800
  ds_read_b64_tr_b16 v[96:97], v14 offset:12288
  ds_read_b64_tr_b16 v[98:99], v14 offset:12800
  ds_read_b64_tr_b16 v[100:101], v14 offset:12320
  ds_read_b64_tr_b16 v[102:103], v14 offset:12832
  ds_read_b64_tr_b16 v[104:105], v14 offset:12352
  ds_read_b64_tr_b16 v[106:107], v14 offset:12864
  ds_read_b64_tr_b16 v[108:109], v14 offset:12384
  ds_read_b64_tr_b16 v[110:111], v14 offset:12896
  s_waitcnt lgkmcnt(12)
  v_mfma_f32_16x16x32_bf16 v[32:35], v[120:123], v[80:83], v[32:35]
  v_mfma_f32_16x16x32_bf16 v[36:39], v[120:123], v[84:87], v[36:39]
  s_waitcnt lgkmcnt(8)
  v_mfma_f32_16x16x32_bf16 v[40:43], v[120:123], v[88:91], v[40:43]
  v_mfma_f32_16x16x32_bf16 v[44:47], v[120:123], v[92:95], v[44:47]
  s_waitcnt lgkmcnt(4)
  v_mfma_f32_16x16x32_bf16 v[48:51], v[112:115], v[96:99], 0
  v_mfma_f32_16x16x32_bf16 v[52:55], v[112:115], v[100:103], 0
  s_waitcnt lgkmcnt(0)
  v_mfma_f32_16x16x32_bf16 v[56:59], v[112:115], v[104:107], 0
  v_mfma_f32_16x16x32_bf16 v[60:63], v[112:115], v[108:111], 0
  s_waitcnt vmcnt(0)
  ds_read_b64_tr_b16 v[80:81], v14 offset:16384
  ds_read_b64_tr_b16 v[82:83], v14 offset:16896
  ds_read_b64_tr_b16 v[84:85], v14 offset:16416
  ds_read_b64_tr_b16 v[86:87], v14 offset:16928
  ds_read_b64_tr_b16 v[88:89], v14 offset:16448
  ds_read_b64_tr_b16 v[90:91], v14 offset:16960
  ds_read_b64_tr_b16 v[92:93], v14 offset:16480
  ds_read_b64_tr_b16 v[94:95], v14 offset:16992
  ds_read_b64_tr_b16 v[96:97], v14 offset:20480
  ds_read_b64_tr_b16 v[98:99], v14 offset:20992
  ds_read_b64_tr_b16 v[100:101], v14 offset:20512
  ds_read_b64_tr_b16 v[102:103], v14 offset:21024
  ds_read_b64_tr_b16 v[104:105], v14 offset:20544
  ds_read_b64_tr_b16 v[106:107], v14 offset:21056
  ds_read_b64_tr_b16 v[108:109], v14 offset:20576
  ds_read_b64_tr_b16 v[110:111], v14 offset:21088
  s_waitcnt lgkmcnt(12)
  v_mfma_f32_16x16x32_bf16 v[48:51], v[116:119], v[80:83], v[48:51]
  v_mfma_f32_16x16x32_bf16 v[52:55], v[116:119], v[84:87], v[52:55]
  s_waitcnt lgkmcnt(8)
  v_mfma_f32_16x16x32_bf16 v[56:59], v[116:119], v[88:91], v[56:59]
  v_mfma_f32_16x16x32_bf16 v[60:63], v[116:119], v[92:95], v[60:63]
  s_waitcnt lgkmcnt(4)
  v_mfma_f32_16x16x32_bf16 v[48:51], v[120:123], v[96:99], v[48:51]
  v_mfma_f32_16x16x32_bf16 v[52:55], v[120:123], v[100:103], v[52:55]
  s_waitcnt lgkmcnt(0)
  v_mfma_f32_16x16x32_bf16 v[56:59], v[120:123], v[104:107], v[56:59]
  v_mfma_f32_16x16x32_bf16 v[60:63], v[120:123], v[108:111], v[60:63]
  s_mov_b32 s8, 0
  s_mov_b32 s9, -1
  s_lshl_b32 s10, s3, 1
  v_add_u32 v14, s10, v24
  v_lshlrev_b32 v14, 11, v14
  v_bfe_u32 v15, v4, 4, 1
  v_lshlrev_b32 v15, 10, v15
  v_add_u32 v14, v14, v15
  v_and_b32 v15, 15, v4
  v_lshlrev_b32 v15, 2, v15
  v_add_u32 v14, v14, v15
  v_add_u32 v14, 106496, v14
  v_mov_b32 v15, 1
  v_cndmask_b32 v32, v32, v48, s[8:9]
  v_cndmask_b32 v33, v33, v49, s[8:9]
  v_cndmask_b32 v34, v34, v50, s[8:9]
  v_cndmask_b32 v35, v35, v51, s[8:9]
  v_cndmask_b32 v36, v36, v52, s[8:9]
  v_cndmask_b32 v37, v37, v53, s[8:9]
  v_cndmask_b32 v38, v38, v54, s[8:9]
  v_cndmask_b32 v39, v39, v55, s[8:9]
  v_cndmask_b32 v40, v40, v56, s[8:9]
  v_cndmask_b32 v41, v41, v57, s[8:9]
  v_cndmask_b32 v42, v42, v58, s[8:9]
  v_cndmask_b32 v43, v43, v59, s[8:9]
  v_cndmask_b32 v44, v44, v60, s[8:9]
  v_cndmask_b32 v45, v45, v61, s[8:9]
  v_cndmask_b32 v46, v46, v62, s[8:9]
  v_cndmask_b32 v47, v47, v63, s[8:9]
  ds_write2_b32 v14, v32, v33 offset0:0 offset1:64
  ds_write2_b32 v14, v34, v35 offset0:128 offset1:192
  ds_write2_b32 v14, v36, v37 offset0:16 offset1:80
  ds_write2_b32 v14, v38, v39 offset0:144 offset1:208
  ds_write2_b32 v14, v40, v41 offset0:32 offset1:96
  ds_write2_b32 v14, v42, v43 offset0:160 offset1:224
  ds_write2_b32 v14, v44, v45 offset0:48 offset1:112
  ds_write2_b32 v14, v46, v47 offset0:176 offset1:240
  v_lshlrev_b32 v14, 8, v8
  v_add_u32 v14, v14, v9
  v_add_u32 v14, 106496, v14
  s_waitcnt lgkmcnt(0)
  s_mov_b64 exec, 1
  ds_add_rtn_u32 v15, v6, v15
  s_waitcnt lgkmcnt(0)
  s_mov_b64 exec, -1
  v_readfirstlane_b32 s8, v15
  s_nop 1
  s_cmp_eq_u32 s8, 2
  s_cbranch_scc0 L_P1_notlast
  ds_read_b128 v[32:35], v14 offset:0
  ds_read_b128 v[36:39], v14 offset:128
  ds_read_b128 v[40:43], v14 offset:2048
  ds_read_b128 v[44:47], v14 offset:2176
  ds_read_b128 v[48:51], v14 offset:4096
  ds_read_b128 v[52:55], v14 offset:4224
  ds_read_b128 v[56:59], v14 offset:6144
  ds_read_b128 v[60:63], v14 offset:6272
  ds_read_b128 v[64:67], v14 offset:8192
  ds_read_b128 v[68:71], v14 offset:8320
  ds_read_b128 v[72:75], v14 offset:10240
  ds_read_b128 v[76:79], v14 offset:10368
  v_mov_b32 v81, v3
  v_mov_b32 v83, v3
  v_mov_b32 v85, v3
  v_mov_b32 v87, v3
  v_mul_u32_u24 v14, 13824, v8
  v_add_u32 v14, v14, v9
  s_lshl_b32 s8, s93, 8
  s_add_u32 s8, s8, 4096
  s_waitcnt lgkmcnt(0)
  v_pk_add_f32 v[32:33], v[32:33], v[40:41]
  v_pk_add_f32 v[34:35], v[34:35], v[42:43]
  v_pk_add_f32 v[36:37], v[36:37], v[44:45]
  v_pk_add_f32 v[38:39], v[38:39], v[46:47]
  v_pk_add_f32 v[32:33], v[32:33], v[48:49]
  v_pk_add_f32 v[34:35], v[34:35], v[50:51]
  v_pk_add_f32 v[36:37], v[36:37], v[52:53]
  v_pk_add_f32 v[38:39], v[38:39], v[54:55]
  v_pk_add_f32 v[32:33], v[32:33], v[56:57]
  v_pk_add_f32 v[34:35], v[34:35], v[58:59]
  v_pk_add_f32 v[36:37], v[36:37], v[60:61]
  v_pk_add_f32 v[38:39], v[38:39], v[62:63]
  v_pk_add_f32 v[32:33], v[32:33], v[64:65]
  v_pk_add_f32 v[34:35], v[34:35], v[66:67]
  v_pk_add_f32 v[36:37], v[36:37], v[68:69]
  v_pk_add_f32 v[38:39], v[38:39], v[70:71]
  v_pk_add_f32 v[32:33], v[32:33], v[72:73]
  v_pk_add_f32 v[34:35], v[34:35], v[74:75]
  v_pk_add_f32 v[36:37], v[36:37], v[76:77]
  v_pk_add_f32 v[38:39], v[38:39], v[78:79]
  v_cvt_pk_bf16_f32 v80, v32, v33
  v_cvt_pk_bf16_f32 v82, v34, v35
  v_cvt_pk_bf16_f32 v84, v36, v37
  v_cvt_pk_bf16_f32 v86, v38, v39
  buffer_store_dwordx4 v[80:83], v14, s[52:55], s8 offen sc1
  buffer_store_dwordx4 v[84:87], v14, s[52:55], s8 offen offset:128 sc1
L_P1_notlast:
  s_mov_b32 s56, s16
  s_mov_b32 s57, s17
  s_mov_b32 s58, 9216
  s_mov_b32 s59, 0x20000
  s_mov_b32 s94, -1
  s_branch L_join
L_notP1:
  s_add_u32 s8, s7, 72
  s_cmp_lt_u32 s7, 120
  s_cselect_b32 s94, s8, s98
  s_cmp_eq_u32 s3, 0
  s_cselect_b32 s94, s94, -1
  s_mov_b32 s56, s16
  s_mov_b32 s57, s17
  s_mov_b32 s58, 9216
  s_mov_b32 s59, 0x20000
  s_mov_b32 s52, s40
  s_mov_b32 s53, s41
  s_mov_b32 s54, 16777216
  s_mov_b32 s55, 0x20000
  buffer_load_dword v3, v5, s[52:55], 0 offen sc1
  s_cmp_eq_u32 s94, -1
  s_cbranch_scc1 L_notP2
  s_mov_b32 s48, s22
  s_mov_b32 s49, s23
  s_mov_b32 s50, 4718592
  s_mov_b32 s51, 0x20000
  v_mul_u32_u24 v14, 1152, v8
  v_add_u32 v14, v14, v9
  buffer_load_dwordx4 v[32:35], v14, s[56:59], 0 offen offset:0
  buffer_load_dwordx4 v[36:39], v14, s[56:59], 0 offen offset:128
  buffer_load_dwordx4 v[40:43], v14, s[56:59], 0 offen offset:256
  buffer_load_dwordx4 v[44:47], v14, s[56:59], 0 offen offset:384
  buffer_load_dwordx4 v[48:51], v14, s[56:59], 0 offen offset:512
  buffer_load_dwordx4 v[52:55], v14, s[56:59], 0 offen offset:640
  buffer_load_dwordx4 v[56:59], v14, s[56:59], 0 offen offset:768
  buffer_load_dwordx4 v[60:63], v14, s[56:59], 0 offen offset:896
  buffer_load_dwordx4 v[64:67], v14, s[56:59], 0 offen offset:1024
  s_lshr_b32 s12, s94, 6
  v_lshlrev_b32 v13, 13, v8
  v_add_u32 v13, v13, v9
  s_mul_i32 s8, s12, 1572864
  s_and_b32 s9, s94, 63
  s_lshl_b32 s9, s9, 7
  s_add_u32 s8, s8, s9
  s_mov_b32 s9, 73728
  s_add_u32 s10, s9, 24576
L_dma_103:
  s_mov_b32 m0, s9
  s_add_u32 s9, s9, 1024
  buffer_load_dwordx4 v13, s[48:51], s8 offen nt lds
  s_add_u32 s8, s8, 65536
  s_cmp_lt_u32 s9, s10
  s_cbranch_scc1 L_dma_103
  s_barrier
  s_mul_i32 s8, s12, 384
  s_mov_b32 s13, 118784
  v_add_u32 v14, 0, v4
  v_mul_u32_u24 v80, 1366, v14
  v_lshrrev_b32 v80, 16, v80
  v_mul_u32_u24 v15, 48, v80
  v_sub_u32 v15, v14, v15
  v_lshlrev_b32 v15, 3, v15
  v_mul_u32_u24 v14, 1152, v80
  v_add_u32 v14, v14, v15
  buffer_load_dwordx2 v[68:69], v14, s[56:59], s8 offen
  v_mul_u32_u24 v92, 13824, v80
  v_lshl_add_u32 v92, v15, 1, v92
  v_mul_u32_u24 v98, 416, v80
  v_add3_u32 v98, v98, v15, s13
  v_lshlrev_b32 v80, 3, v80
  v_add_u32 v80, s13, v80
  v_add_u32 v14, 64, v4
  v_mul_u32_u24 v81, 1366, v14
  v_lshrrev_b32 v81, 16, v81
  v_mul_u32_u24 v15, 48, v81
  v_sub_u32 v15, v14, v15
  v_lshlrev_b32 v15, 3, v15
  v_mul_u32_u24 v14, 1152, v81
  v_add_u32 v14, v14, v15
  buffer_load_dwordx2 v[70:71], v14, s[56:59], s8 offen
  v_mul_u32_u24 v93, 13824, v81
  v_lshl_add_u32 v93, v15, 1, v93
  v_mul_u32_u24 v99, 416, v81
  v_add3_u32 v99, v99, v15, s13
  v_lshlrev_b32 v81, 3, v81
  v_add_u32 v81, s13, v81
  v_add_u32 v14, 128, v4
  v_mul_u32_u24 v82, 1366, v14
  v_lshrrev_b32 v82, 16, v82
  v_mul_u32_u24 v15, 48, v82
  v_sub_u32 v15, v14, v15
  v_lshlrev_b32 v15, 3, v15
  v_mul_u32_u24 v14, 1152, v82
  v_add_u32 v14, v14, v15
  buffer_load_dwordx2 v[72:73], v14, s[56:59], s8 offen
  v_mul_u32_u24 v94, 13824, v82
  v_lshl_add_u32 v94, v15, 1, v94
  v_mul_u32_u24 v100, 416, v82
  v_add3_u32 v100, v100, v15, s13
  v_lshlrev_b32 v82, 3, v82
  v_add_u32 v82, s13, v82
  v_add_u32 v14, 192, v4
  v_mul_u32_u24 v83, 1366, v14
  v_lshrrev_b32 v83, 16, v83
  v_mul_u32_u24 v15, 48, v83
  v_sub_u32 v15, v14, v15
  v_lshlrev_b32 v15, 3, v15
  v_mul_u32_u24 v14, 1152, v83
  v_add_u32 v14, v14, v15
  buffer_load_dwordx2 v[74:75], v14, s[56:59], s8 offen
  v_mul_u32_u24 v95, 13824, v83
  v_lshl_add_u32 v95, v15, 1, v95
  v_mul_u32_u24 v101, 416, v83
  v_add3_u32 v101, v101, v15, s13
  v_lshlrev_b32 v83, 3, v83
  v_add_u32 v83, s13, v83
  v_add_u32 v14, 256, v4
  v_mul_u32_u24 v84, 1366, v14
  v_lshrrev_b32 v84, 16, v84
  v_mul_u32_u24 v15, 48, v84
  v_sub_u32 v15, v14, v15
  v_lshlrev_b32 v15, 3, v15
  v_mul_u32_u24 v14, 1152, v84
  v_add_u32 v14, v14, v15
  buffer_load_dwordx2 v[76:77], v14, s[56:59], s8 offen
  v_mul_u32_u24 v96, 13824, v84
  v_lshl_add_u32 v96, v15, 1, v96
  v_mul_u32_u24 v102, 416, v84
  v_add3_u32 v102, v102, v15, s13
  v_lshlrev_b32 v84, 3, v84
  v_add_u32 v84, s13, v84
  v_add_u32 v14, 320, v4
  v_mul_u32_u24 v85, 1366, v14
  v_lshrrev_b32 v85, 16, v85
  v_mul_u32_u24 v15, 48, v85
  v_sub_u32 v15, v14, v15
  v_lshlrev_b32 v15, 3, v15
  v_mul_u32_u24 v14, 1152, v85
  v_add_u32 v14, v14, v15
  buffer_load_dwordx2 v[78:79], v14, s[56:59], s8 offen
  v_mul_u32_u24 v97, 13824, v85
  v_lshl_add_u32 v97, v15, 1, v97
  v_mul_u32_u24 v103, 416, v85
  v_add3_u32 v103, v103, v15, s13
  v_lshlrev_b32 v85, 3, v85
  v_add_u32 v85, s13, v85
  v_lshrrev_b32 v10, 4, v4
  v_lshlrev_b32 v10, 3, v10
  v_bfe_u32 v11, v4, 2, 2
  v_add_u32 v11, v10, v11
  v_lshlrev_b32 v10, 7, v11
  v_and_b32 v12, 3, v4
  v_lshlrev_b32 v12, 3, v12
  v_add_u32 v10, v10, v12
  v_lshrrev_b32 v24, 5, v4
  v_and_b32 v25, 31, v4
  s_waitcnt vmcnt(30)
  v_add_u32 v3, 2654435769, v3
  v_lshlrev_b32 v160, 16, v32
  v_and_b32 v161, 0xffff0000, v32
  v_lshlrev_b32 v162, 16, v33
  v_and_b32 v163, 0xffff0000, v33
  v_lshlrev_b32 v164, 16, v34
  v_and_b32 v165, 0xffff0000, v34
  v_lshlrev_b32 v166, 16, v35
  v_and_b32 v167, 0xffff0000, v35
  v_lshlrev_b32 v168, 16, v36
  v_and_b32 v169, 0xffff0000, v36
  v_lshlrev_b32 v170, 16, v37
  v_and_b32 v171, 0xffff0000, v37
  v_lshlrev_b32 v172, 16, v38
  v_and_b32 v173, 0xffff0000, v38
  v_lshlrev_b32 v174, 16, v39
  v_and_b32 v175, 0xffff0000, v39
  v_lshlrev_b32 v176, 16, v40
  v_and_b32 v177, 0xffff0000, v40
  v_lshlrev_b32 v178, 16, v41
  v_and_b32 v179, 0xffff0000, v41
  v_lshlrev_b32 v180, 16, v42
  v_and_b32 v181, 0xffff0000, v42
  v_lshlrev_b32 v182, 16, v43
  v_and_b32 v183, 0xffff0000, v43
  v_lshlrev_b32 v184, 16, v44
  v_and_b32 v185, 0xffff0000, v44
  v_lshlrev_b32 v186, 16, v45
  v_and_b32 v187, 0xffff0000, v45
  v_lshlrev_b32 v188, 16, v46
  v_and_b32 v189, 0xffff0000, v46
  v_lshlrev_b32 v190, 16, v47
  v_and_b32 v191, 0xffff0000, v47
  v_lshlrev_b32 v192, 16, v48
  v_and_b32 v193, 0xffff0000, v48
  v_lshlrev_b32 v194, 16, v49
  v_and_b32 v195, 0xffff0000, v49
  v_lshlrev_b32 v196, 16, v50
  v_and_b32 v197, 0xffff0000, v50
  v_lshlrev_b32 v198, 16, v51
  v_and_b32 v199, 0xffff0000, v51
  v_lshlrev_b32 v200, 16, v52
  v_and_b32 v201, 0xffff0000, v52
  v_lshlrev_b32 v202, 16, v53
  v_and_b32 v203, 0xffff0000, v53
  v_lshlrev_b32 v204, 16, v54
  v_and_b32 v205, 0xffff0000, v54
  v_lshlrev_b32 v206, 16, v55
  v_and_b32 v207, 0xffff0000, v55
  v_lshlrev_b32 v208, 16, v56
  v_and_b32 v209, 0xffff0000, v56
  v_lshlrev_b32 v210, 16, v57
  v_and_b32 v211, 0xffff0000, v57
  v_lshlrev_b32 v212, 16, v58
  v_and_b32 v213, 0xffff0000, v58
  v_lshlrev_b32 v214, 16, v59
  v_and_b32 v215, 0xffff0000, v59
  v_lshlrev_b32 v216, 16, v60
  v_and_b32 v217, 0xffff0000, v60
  v_lshlrev_b32 v218, 16, v61
  v_and_b32 v219, 0xffff0000, v61
  v_lshlrev_b32 v220, 16, v62
  v_and_b32 v221, 0xffff0000, v62
  v_lshlrev_b32 v222, 16, v63
  v_and_b32 v223, 0xffff0000, v63
  v_lshlrev_b32 v224, 16, v64
  v_and_b32 v225, 0xffff0000, v64
  v_lshlrev_b32 v226, 16, v65
  v_and_b32 v227, 0xffff0000, v65
  v_lshlrev_b32 v228, 16, v66
  v_and_b32 v229, 0xffff0000, v66
  v_lshlrev_b32 v230, 16, v67
  v_and_b32 v231, 0xffff0000, v67
  v_pk_add_f32 v[16:17], v[160:161], v[162:163]
  v_pk_add_f32 v[18:19], v[164:165], v[166:167]
  v_pk_add_f32 v[16:17], v[16:17], v[168:169]
  v_pk_add_f32 v[18:19], v[18:19], v[170:171]
  v_pk_add_f32 v[16:17], v[16:17], v[172:173]
  v_pk_add_f32 v[18:19], v[18:19], v[174:175]
  v_pk_add_f32 v[16:17], v[16:17], v[176:177]
  v_pk_add_f32 v[18:19], v[18:19], v[178:179]
  v_pk_add_f32 v[16:17], v[16:17], v[180:181]
  v_pk_add_f32 v[18:19], v[18:19], v[182:183]
  v_pk_add_f32 v[16:17], v[16:17], v[184:185]
  v_pk_add_f32 v[18:19], v[18:19], v[186:187]
  v_pk_add_f32 v[16:17], v[16:17], v[188:189]
  v_pk_add_f32 v[18:19], v[18:19], v[190:191]
  v_pk_add_f32 v[16:17], v[16:17], v[192:193]
  v_pk_add_f32 v[18:19], v[18:19], v[194:195]
  v_pk_add_f32 v[16:17], v[16:17], v[196:197]
  v_pk_add_f32 v[18:19], v[18:19], v[198:199]
  v_pk_add_f32 v[16:17], v[16:17], v[200:201]
  v_pk_add_f32 v[18:19], v[18:19], v[202:203]
  v_pk_add_f32 v[16:17], v[16:17], v[204:205]
  v_pk_add_f32 v[18:19], v[18:19], v[206:207]
  v_pk_add_f32 v[16:17], v[16:17], v[208:209]
  v_pk_add_f32 v[18:19], v[18:19], v[210:211]
  v_pk_add_f32 v[16:17], v[16:17], v[212:213]
  v_pk_add_f32 v[18:19], v[18:19], v[214:215]
  v_pk_add_f32 v[16:17], v[16:17], v[216:217]
  v_pk_add_f32 v[18:19], v[18:19], v[218:219]
  v_pk_add_f32 v[16:17], v[16:17], v[220:221]
  v_pk_add_f32 v[18:19], v[18:19], v[222:223]
  v_pk_add_f32 v[16:17], v[16:17], v[224:225]
  v_pk_add_f32 v[18:19], v[18:19], v[226:227]
  v_pk_add_f32 v[16:17], v[16:17], v[228:229]
  v_pk_add_f32 v[18:19], v[18:19], v[230:231]
  v_pk_add_f32 v[16:17], v[16:17], v[18:19]
  v_add_f32 v16, v16, v17
  s_nop 1
  v_add_f32_dpp v16, v16, v16 quad_perm:[1,0,3,2] row_mask:0xf bank_mask:0xf
  s_nop 1
  v_add_f32_dpp v16, v16, v16 quad_perm:[2,3,0,1] row_mask:0xf bank_mask:0xf
  s_nop 1
  v_add_f32_dpp v16, v16, v16 row_half_mirror row_mask:0xf bank_mask:0xf
  v_mul_f32 v16, 987991609, v16
  v_mov_b32 v20, 0
  v_mov_b32 v21, 0
  v_mov_b32 v22, 0
  v_mov_b32 v23, 0
  v_mov_b32 v17, v16
  v_pk_add_f32 v[160:161], v[160:161], v[16:17] neg_lo:[0,1] neg_hi:[0,1]
  v_pk_add_f32 v[162:163], v[162:163], v[16:17] neg_lo:[0,1] neg_hi:[0,1]
  v_pk_add_f32 v[164:165], v[164:165], v[16:17] neg_lo:[0,1] neg_hi:[0,1]
  v_pk_add_f32 v[166:167], v[166:167], v[16:17] neg_lo:[0,1] neg_hi:[0,1]
  v_pk_add_f32 v[168:169], v[168:169], v[16:17] neg_lo:[0,1] neg_hi:[0,1]
  v_pk_add_f32 v[170:171], v[170:171], v[16:17] neg_lo:[0,1] neg_hi:[0,1]
  v_pk_add_f32 v[172:173], v[172:173], v[16:17] neg_lo:[0,1] neg_hi:[0,1]
  v_pk_add_f32 v[174:175], v[174:175], v[16:17] neg_lo:[0,1] neg_hi:[0,1]
  v_pk_add_f32 v[176:177], v[176:177], v[16:17] neg_lo:[0,1] neg_hi:[0,1]
  v_pk_add_f32 v[178:179], v[178:179], v[16:17] neg_lo:[0,1] neg_hi:[0,1]
  v_pk_add_f32 v[180:181], v[180:181], v[16:17] neg_lo:[0,1] neg_hi:[0,1]
  v_pk_add_f32 v[182:183], v[182:183], v[16:17] neg_lo:[0,1] neg_hi:[0,1]
  v_pk_add_f32 v[184:185], v[184:185], v[16:17] neg_lo:[0,1] neg_hi:[0,1]
  v_pk_add_f32 v[186:187], v[186:187], v[16:17] neg_lo:[0,1] neg_hi:[0,1]
  v_pk_add_f32 v[188:189], v[188:189], v[16:17] neg_lo:[0,1] neg_hi:[0,1]
  v_pk_add_f32 v[190:191], v[190:191], v[16:17] neg_lo:[0,1] neg_hi:[0,1]
  v_pk_add_f32 v[192:193], v[192:193], v[16:17] neg_lo:[0,1] neg_hi:[0,1]
  v_pk_add_f32 v[194:195], v[194:195], v[16:17] neg_lo:[0,1] neg_hi:[0,1]
  v_pk_add_f32 v[196:197], v[196:197], v[16:17] neg_lo:[0,1] neg_hi:[0,1]
  v_pk_add_f32 v[198:199], v[198:199], v[16:17] neg_lo:[0,1] neg_hi:[0,1]
  v_pk_add_f32 v[200:201], v[200:201], v[16:17] neg_lo:[0,1] neg_hi:[0,1]
  v_pk_add_f32 v[202:203], v[202:203], v[16:17] neg_lo:[0,1] neg_hi:[0,1]
  v_pk_add_f32 v[204:205], v[204:205], v[16:17] neg_lo:[0,1] neg_hi:[0,1]
  v_pk_add_f32 v[206:207], v[206:207], v[16:17] neg_lo:[0,1] neg_hi:[0,1]
  v_pk_add_f32 v[208:209], v[208:209], v[16:17] neg_lo:[0,1] neg_hi:[0,1]
  v_pk_add_f32 v[210:211], v[210:211], v[16:17] neg_lo:[0,1] neg_hi:[0,1]
  v_pk_add_f32 v[212:213], v[212:213], v[16:17] neg_lo:[0,1] neg_hi:[0,1]
  v_pk_add_f32 v[214:215], v[214:215], v[16:17] neg_lo:[0,1] neg_hi:[0,1]
  v_pk_add_f32 v[216:217], v[216:217], v[16:17] neg_lo:[0,1] neg_hi:[0,1]
  v_pk_add_f32 v[218:219], v[218:219], v[16:17] neg_lo:[0,1] neg_hi:[0,1]
  v_pk_add_f32 v[220:221], v[220:221], v[16:17] neg_lo:[0,1] neg_hi:[0,1]
  v_pk_add_f32 v[222:223], v[222:223], v[16:17] neg_lo:[0,1] neg_hi:[0,1]
  v_pk_add_f32 v[224:225], v[224:225], v[16:17] neg_lo:[0,1] neg_hi:[0,1]
  v_pk_add_f32 v[226:227], v[226:227], v[16:17] neg_lo:[0,1] neg_hi:[0,1]
  v_pk_add_f32 v[228:229], v[228:229], v[16:17] neg_lo:[0,1] neg_hi:[0,1]
  v_pk_add_f32 v[230:231], v[230:231], v[16:17] neg_lo:[0,1] neg_hi:[0,1]
  v_pk_fma_f32 v[20:21], v[160:161], v[160:161], v[20:21]
  v_pk_fma_f32 v[22:23], v[162:163], v[162:163], v[22:23]
  v_pk_fma_f32 v[20:21], v[164:165], v[164:165], v[20:21]
  v_pk_fma_f32 v[22:23], v[166:167], v[166:167], v[22:23]
  v_pk_fma_f32 v[20:21], v[168:169], v[168:169], v[20:21]
  v_pk_fma_f32 v[22:23], v[170:171], v[170:171], v[22:23]
  v_pk_fma_f32 v[20:21], v[172:173], v[172:173], v[20:21]
  v_pk_fma_f32 v[22:23], v[174:175], v[174:175], v[22:23]
  v_pk_fma_f32 v[20:21], v[176:177], v[176:177], v[20:21]
  v_pk_fma_f32 v[22:23], v[178:179], v[178:179], v[22:23]
  v_pk_fma_f32 v[20:21], v[180:181], v[180:181], v[20:21]
  v_pk_fma_f32 v[22:23], v[182:183], v[182:183], v[22:23]
  v_pk_fma_f32 v[20:21], v[184:185], v[184:185], v[20:21]
  v_pk_fma_f32 v[22:23], v[186:187], v[186:187], v[22:23]
  v_pk_fma_f32 v[20:21], v[188:189], v[188:189], v[20:21]
  v_pk_fma_f32 v[22:23], v[190:191], v[190:191], v[22:23]
  v_pk_fma_f32 v[20:21], v[192:193], v[192:193], v[20:21]
  v_pk_fma_f32 v[22:23], v[194:195], v[194:195], v[22:23]
  v_pk_fma_f32 v[20:21], v[196:197], v[196:197], v[20:21]
  v_pk_fma_f32 v[22:23], v[198:199], v[198:199], v[22:23]
  v_pk_fma_f32 v[20:21], v[200:201], v[200:201], v[20:21]
  v_pk_fma_f32 v[22:23], v[202:203], v[202:203], v[22:23]
  v_pk_fma_f32 v[20:21], v[204:205], v[204:205], v[20:21]
  v_pk_fma_f32 v[22:23], v[206:207], v[206:207], v[22:23]
  v_pk_fma_f32 v[20:21], v[208:209], v[208:209], v[20:21]
  v_pk_fma_f32 v[22:23], v[210:211], v[210:211], v[22:23]
  v_pk_fma_f32 v[20:21], v[212:213], v[212:213], v[20:21]
  v_pk_fma_f32 v[22:23], v[214:215], v[214:215], v[22:23]
  v_pk_fma_f32 v[20:21], v[216:217], v[216:217], v[20:21]
  v_pk_fma_f32 v[22:23], v[218:219], v[218:219], v[22:23]
  v_pk_fma_f32 v[20:21], v[220:221], v[220:221], v[20:21]
  v_pk_fma_f32 v[22:23], v[222:223], v[222:223], v[22:23]
  v_pk_fma_f32 v[20:21], v[224:225], v[224:225], v[20:21]
  v_pk_fma_f32 v[22:23], v[226:227], v[226:227], v[22:23]
  v_pk_fma_f32 v[20:21], v[228:229], v[228:229], v[20:21]
  v_pk_fma_f32 v[22:23], v[230:231], v[230:231], v[22:23]
  v_pk_add_f32 v[20:21], v[20:21], v[22:23]
  v_add_f32 v17, v20, v21
  s_nop 1
  v_add_f32_dpp v17, v17, v17 quad_perm:[1,0,3,2] row_mask:0xf bank_mask:0xf
  s_nop 1
  v_add_f32_dpp v17, v17, v17 quad_perm:[2,3,0,1] row_mask:0xf bank_mask:0xf
  s_nop 1
  v_add_f32_dpp v17, v17, v17 row_half_mirror row_mask:0xf bank_mask:0xf
  v_mul_f32 v17, 987991609, v17
  v_cvt_pk_bf16_f32 v17, v17, v17
  v_lshlrev_b32 v17, 16, v17
  v_cvt_pk_bf16_f32 v16, v16, v16
  v_lshlrev_b32 v16, 16, v16
  v_add_f32 v17, 925353388, v17
  v_cvt_pk_bf16_f32 v17, v17, v17
  v_lshlrev_b32 v17, 16, v17
  v_sqrt_f32 v17, v17
  s_nop 0
  v_cvt_pk_bf16_f32 v17, v17, v17
  v_lshlrev_b32 v17, 16, v17
  v_rcp_f32 v17, v17
  v_lshlrev_b32 v14, 3, v8
  v_add_u32 v14, s13, v14
  ds_write_b64 v14, v[16:17] offset:3328
  s_waitcnt lgkmcnt(0)
  ds_read_b64 v[104:105], v80 offset:3328
  ds_read_b64 v[106:107], v81 offset:3328
  ds_read_b64 v[108:109], v82 offset:3328
  ds_read_b64 v[110:111], v83 offset:3328
  ds_read_b64 v[112:113], v84 offset:3328
  ds_read_b64 v[114:115], v85 offset:3328
  v_add_u32 v14, 73728, v10
  s_waitcnt vmcnt(0) lgkmcnt(0)
  ds_read_b64_tr_b16 v[160:161], v14 offset:0
  ds_read_b64_tr_b16 v[162:163], v14 offset:512
  ds_read_b64_tr_b16 v[164:165], v14 offset:32
  ds_read_b64_tr_b16 v[166:167], v14 offset:544
  ds_read_b64_tr_b16 v[168:169], v14 offset:64
  ds_read_b64_tr_b16 v[170:171], v14 offset:576
  ds_read_b64_tr_b16 v[172:173], v14 offset:96
  ds_read_b64_tr_b16 v[174:175], v14 offset:608
  ds_read_b64_tr_b16 v[176:177], v14 offset:4096
  ds_read_b64_tr_b16 v[178:179], v14 offset:4608
  ds_read_b64_tr_b16 v[180:181], v14 offset:4128
  ds_read_b64_tr_b16 v[182:183], v14 offset:4640
  ds_read_b64_tr_b16 v[184:185], v14 offset:4160
  ds_read_b64_tr_b16 v[186:187], v14 offset:4672
  ds_read_b64_tr_b16 v[188:189], v14 offset:4192
  ds_read_b64_tr_b16 v[190:191], v14 offset:4704
  ds_read_b64_tr_b16 v[192:193], v14 offset:8192
  ds_read_b64_tr_b16 v[194:195], v14 offset:8704
  ds_read_b64_tr_b16 v[196:197], v14 offset:8224
  ds_read_b64_tr_b16 v[198:199], v14 offset:8736
  ds_read_b64_tr_b16 v[200:201], v14 offset:8256
  ds_read_b64_tr_b16 v[202:203], v14 offset:8768
  ds_read_b64_tr_b16 v[204:205], v14 offset:8288
  ds_read_b64_tr_b16 v[206:207], v14 offset:8800
  ds_read_b64_tr_b16 v[208:209], v14 offset:12288
  ds_read_b64_tr_b16 v[210:211], v14 offset:12800
  ds_read_b64_tr_b16 v[212:213], v14 offset:12320
  ds_read_b64_tr_b16 v[214:215], v14 offset:12832
  ds_read_b64_tr_b16 v[216:217], v14 offset:12352
  ds_read_b64_tr_b16 v[218:219], v14 offset:12864
  ds_read_b64_tr_b16 v[220:221], v14 offset:12384
  ds_read_b64_tr_b16 v[222:223], v14 offset:12896
  ds_read_b64_tr_b16 v[224:225], v14 offset:16384
  ds_read_b64_tr_b16 v[226:227], v14 offset:16896
  ds_read_b64_tr_b16 v[228:229], v14 offset:16416
  ds_read_b64_tr_b16 v[230:231], v14 offset:16928
  ds_read_b64_tr_b16 v[232:233], v14 offset:16448
  ds_read_b64_tr_b16 v[234:235], v14 offset:16960
  ds_read_b64_tr_b16 v[236:237], v14 offset:16480
  ds_read_b64_tr_b16 v[238:239], v14 offset:16992
  ds_read_b64_tr_b16 v[240:241], v14 offset:20480
  ds_read_b64_tr_b16 v[242:243], v14 offset:20992
  ds_read_b64_tr_b16 v[244:245], v14 offset:20512
  ds_read_b64_tr_b16 v[246:247], v14 offset:21024
  ds_read_b64_tr_b16 v[248:249], v14 offset:20544
  ds_read_b64_tr_b16 v[250:251], v14 offset:21056
  ds_read_b64_tr_b16 v[252:253], v14 offset:20576
  ds_read_b64_tr_b16 v[254:255], v14 offset:21088
  v_lshlrev_b32 v32, 16, v68
  v_and_b32 v33, 0xffff0000, v68
  v_sub_f32 v32, v32, v104
  v_sub_f32 v33, v33, v104
  v_cvt_pk_bf16_f32 v68, v32, v33
  v_lshlrev_b32 v32, 16, v68
  v_and_b32 v33, 0xffff0000, v68
  v_mul_f32 v32, v32, v105
  v_mul_f32 v33, v33, v105
  v_cvt_pk_bf16_f32 v68, v32, v33
  v_lshlrev_b32 v32, 16, v68
  v_and_b32 v33, 0xffff0000, v68
  v_lshlrev_b32 v34, 16, v69
  v_and_b32 v35, 0xffff0000, v69
  v_sub_f32 v34, v34, v104
  v_sub_f32 v35, v35, v104
  v_cvt_pk_bf16_f32 v69, v34, v35
  v_lshlrev_b32 v34, 16, v69
  v_and_b32 v35, 0xffff0000, v69
  v_mul_f32 v34, v34, v105
  v_mul_f32 v35, v35, v105
  v_cvt_pk_bf16_f32 v69, v34, v35
  v_lshlrev_b32 v34, 16, v69
  v_and_b32 v35, 0xffff0000, v69
  v_lshlrev_b32 v36, 16, v70
  v_and_b32 v37, 0xffff0000, v70
  v_sub_f32 v36, v36, v106
  v_sub_f32 v37, v37, v106
  v_cvt_pk_bf16_f32 v70, v36, v37
  v_lshlrev_b32 v36, 16, v70
  v_and_b32 v37, 0xffff0000, v70
  v_mul_f32 v36, v36, v107
  v_mul_f32 v37, v37, v107
  v_cvt_pk_bf16_f32 v70, v36, v37
  v_lshlrev_b32 v36, 16, v70
  v_and_b32 v37, 0xffff0000, v70
  v_lshlrev_b32 v38, 16, v71
  v_and_b32 v39, 0xffff0000, v71
  v_sub_f32 v38, v38, v106
  v_sub_f32 v39, v39, v106
  v_cvt_pk_bf16_f32 v71, v38, v39
  v_lshlrev_b32 v38, 16, v71
  v_and_b32 v39, 0xffff0000, v71
  v_mul_f32 v38, v38, v107
  v_mul_f32 v39, v39, v107
  v_cvt_pk_bf16_f32 v71, v38, v39
  v_lshlrev_b32 v38, 16, v71
  v_and_b32 v39, 0xffff0000, v71
  v_lshlrev_b32 v40, 16, v72
  v_and_b32 v41, 0xffff0000, v72
  v_sub_f32 v40, v40, v108
  v_sub_f32 v41, v41, v108
  v_cvt_pk_bf16_f32 v72, v40, v41
  v_lshlrev_b32 v40, 16, v72
  v_and_b32 v41, 0xffff0000, v72
  v_mul_f32 v40, v40, v109
  v_mul_f32 v41, v41, v109
  v_cvt_pk_bf16_f32 v72, v40, v41
  v_lshlrev_b32 v40, 16, v72
  v_and_b32 v41, 0xffff0000, v72
  v_lshlrev_b32 v42, 16, v73
  v_and_b32 v43, 0xffff0000, v73
  v_sub_f32 v42, v42, v108
  v_sub_f32 v43, v43, v108
  v_cvt_pk_bf16_f32 v73, v42, v43
  v_lshlrev_b32 v42, 16, v73
  v_and_b32 v43, 0xffff0000, v73
  v_mul_f32 v42, v42, v109
  v_mul_f32 v43, v43, v109
  v_cvt_pk_bf16_f32 v73, v42, v43
  v_lshlrev_b32 v42, 16, v73
  v_and_b32 v43, 0xffff0000, v73
  v_lshlrev_b32 v44, 16, v74
  v_and_b32 v45, 0xffff0000, v74
  v_sub_f32 v44, v44, v110
  v_sub_f32 v45, v45, v110
  v_cvt_pk_bf16_f32 v74, v44, v45
  v_lshlrev_b32 v44, 16, v74
  v_and_b32 v45, 0xffff0000, v74
  v_mul_f32 v44, v44, v111
  v_mul_f32 v45, v45, v111
  v_cvt_pk_bf16_f32 v74, v44, v45
  v_lshlrev_b32 v44, 16, v74
  v_and_b32 v45, 0xffff0000, v74
  v_lshlrev_b32 v46, 16, v75
  v_and_b32 v47, 0xffff0000, v75
  v_sub_f32 v46, v46, v110
  v_sub_f32 v47, v47, v110
  v_cvt_pk_bf16_f32 v75, v46, v47
  v_lshlrev_b32 v46, 16, v75
  v_and_b32 v47, 0xffff0000, v75
  v_mul_f32 v46, v46, v111
  v_mul_f32 v47, v47, v111
  v_cvt_pk_bf16_f32 v75, v46, v47
  v_lshlrev_b32 v46, 16, v75
  v_and_b32 v47, 0xffff0000, v75
  v_lshlrev_b32 v48, 16, v76
  v_and_b32 v49, 0xffff0000, v76
  v_sub_f32 v48, v48, v112
  v_sub_f32 v49, v49, v112
  v_cvt_pk_bf16_f32 v76, v48, v49
  v_lshlrev_b32 v48, 16, v76
  v_and_b32 v49, 0xffff0000, v76
  v_mul_f32 v48, v48, v113
  v_mul_f32 v49, v49, v113
  v_cvt_pk_bf16_f32 v76, v48, v49
  v_lshlrev_b32 v48, 16, v76
  v_and_b32 v49, 0xffff0000, v76
  v_lshlrev_b32 v50, 16, v77
  v_and_b32 v51, 0xffff0000, v77
  v_sub_f32 v50, v50, v112
  v_sub_f32 v51, v51, v112
  v_cvt_pk_bf16_f32 v77, v50, v51
  v_lshlrev_b32 v50, 16, v77
  v_and_b32 v51, 0xffff0000, v77
  v_mul_f32 v50, v50, v113
  v_mul_f32 v51, v51, v113
  v_cvt_pk_bf16_f32 v77, v50, v51
  v_lshlrev_b32 v50, 16, v77
  v_and_b32 v51, 0xffff0000, v77
  v_lshlrev_b32 v52, 16, v78
  v_and_b32 v53, 0xffff0000, v78
  v_sub_f32 v52, v52, v114
  v_sub_f32 v53, v53, v114
  v_cvt_pk_bf16_f32 v78, v52, v53
  v_lshlrev_b32 v52, 16, v78
  v_and_b32 v53, 0xffff0000, v78
  v_mul_f32 v52, v52, v115
  v_mul_f32 v53, v53, v115
  v_cvt_pk_bf16_f32 v78, v52, v53
  v_lshlrev_b32 v52, 16, v78
  v_and_b32 v53, 0xffff0000, v78
  v_lshlrev_b32 v54, 16, v79
  v_and_b32 v55, 0xffff0000, v79
  v_sub_f32 v54, v54, v114
  v_sub_f32 v55, v55, v114
  v_cvt_pk_bf16_f32 v79, v54, v55
  v_lshlrev_b32 v54, 16, v79
  v_and_b32 v55, 0xffff0000, v79
  v_mul_f32 v54, v54, v115
  v_mul_f32 v55, v55, v115
  v_cvt_pk_bf16_f32 v79, v54, v55
  v_lshlrev_b32 v54, 16, v79
  v_and_b32 v55, 0xffff0000, v79
  v_mov_b32 v28, 1.0
  v_mov_b32 v29, 1.0
  s_mul_i32 s15, s12, 768
  s_add_u32 s15, s15, 4096
  v_and_b32 v30, 7, v4
  v_mul_u32_u24 v30, 416, v30
  v_lshrrev_b32 v15, 4, v4
  v_lshlrev_b32 v15, 4, v15
  v_add3_u32 v30, v30, v15, s13
  v_bfe_u32 v31, v4, 4, 1
  v_lshlrev_b32 v31, 17, v31
  v_and_b32 v15, 15, v4
  v_lshlrev_b32 v15, 3, v15
  v_add_u32 v31, v31, v15
  s_lshl_b32 s14, s12, 18
  s_and_b32 s9, s94, 63
  s_lshl_b32 s9, s9, 9
  s_add_u32 s14, s14, s9
  s_add_u32 s14, s14, 131072
  s_waitcnt lgkmcnt(0)
  s_mov_b64 s[42:43], 0
  s_mov_b64 exec, 0
L_p2_go:
  s_mov_b64 s[66:67], s[42:43]
  s_mov_b64 s[68:69], s[42:43]
  s_mov_b64 s[70:71], s[42:43]
  s_mov_b64 s[72:73], s[42:43]
  s_mov_b64 s[74:75], s[42:43]
  s_mov_b64 s[76:77], s[42:43]
  s_mov_b64 s[78:79], s[42:43]
  s_mov_b64 s[80:81], s[42:43]
  s_mov_b64 s[82:83], s[42:43]
  s_mov_b64 s[84:85], s[42:43]
  s_mov_b64 s[86:87], s[42:43]
  s_mov_b64 s[88:89], s[42:43]
  s_mov_b32 s92, 300000
L_g_104:
  s_mov_b64 exec, s[66:67]
  s_cbranch_execz L_gs_106
  buffer_load_dwordx4 v[104:107], v92, s[52:55], s15 offen sc1
L_gs_106:
  s_mov_b64 exec, s[68:69]
  s_cbranch_execz L_gs_107
  buffer_load_dwordx4 v[108:111], v92, s[52:55], s15 offen offset:2304 sc1
L_gs_107:
  s_mov_b64 exec, s[70:71]
  s_cbranch_execz L_gs_108
  buffer_load_dwordx4 v[112:115], v93, s[52:55], s15 offen sc1
L_gs_108:
  s_mov_b64 exec, s[72:73]
  s_cbranch_execz L_gs_109
  buffer_load_dwordx4 v[116:119], v93, s[52:55], s15 offen offset:2304 sc1
L_gs_109:
  s_mov_b64 exec, s[74:75]
  s_cbranch_execz L_gs_110
  buffer_load_dwordx4 v[120:123], v94, s[52:55], s15 offen sc1
L_gs_110:
  s_mov_b64 exec, s[76:77]
  s_cbranch_execz L_gs_111
  buffer_load_dwordx4 v[124:127], v94, s[52:55], s15 offen offset:2304 sc1
L_gs_111:
  s_mov_b64 exec, s[78:79]
  s_cbranch_execz L_gs_112
  buffer_load_dwordx4 v[128:131], v95, s[52:55], s15 offen sc1
L_gs_112:
  s_mov_b64 exec, s[80:81]
  s_cbranch_execz L_gs_113
  buffer_load_dwordx4 v[132:135], v95, s[52:55], s15 offen offset:2304 sc1
L_gs_113:
  s_mov_b64 exec, s[82:83]
  s_cbranch_execz L_gs_114
  buffer_load_dwordx4 v[136:139], v96, s[52:55], s15 offen sc1
L_gs_114:
  s_mov_b64 exec, s[84:85]
  s_cbranch_execz L_gs_115
  buffer_load_dwordx4 v[140:143], v96, s[52:55], s15 offen offset:2304 sc1
L_gs_115:
  s_mov_b64 exec, s[86:87]
  s_cbranch_execz L_gs_116
  buffer_load_dwordx4 v[144:147], v97, s[52:55], s15 offen sc1
L_gs_116:
  s_mov_b64 exec, s[88:89]
  s_cbranch_execz L_gs_117
  buffer_load_dwordx4 v[148:151], v97, s[52:55], s15 offen offset:2304 sc1
L_gs_117:
  s_mov_b64 exec, s[42:43]
  s_waitcnt vmcnt(0)
  v_xor_b32 v26, v3, v105
  v_xor_b32 v27, v3, v107
  v_bitop3_b32 v26, v26, v109, v3 bitop3:0xf6
  v_bitop3_b32 v27, v27, v111, v3 bitop3:0xf6
  v_bitop3_b32 v26, v26, v113, v3 bitop3:0xf6
  v_bitop3_b32 v27, v27, v115, v3 bitop3:0xf6
  v_bitop3_b32 v26, v26, v117, v3 bitop3:0xf6
  v_bitop3_b32 v27, v27, v119, v3 bitop3:0xf6
  v_bitop3_b32 v26, v26, v121, v3 bitop3:0xf6
  v_bitop3_b32 v27, v27, v123, v3 bitop3:0xf6
  v_bitop3_b32 v26, v26, v125, v3 bitop3:0xf6
  v_bitop3_b32 v27, v27, v127, v3 bitop3:0xf6
  v_bitop3_b32 v26, v26, v129, v3 bitop3:0xf6
  v_bitop3_b32 v27, v27, v131, v3 bitop3:0xf6
  v_bitop3_b32 v26, v26, v133, v3 bitop3:0xf6
  v_bitop3_b32 v27, v27, v135, v3 bitop3:0xf6
  v_bitop3_b32 v26, v26, v137, v3 bitop3:0xf6
  v_bitop3_b32 v27, v27, v139, v3 bitop3:0xf6
  v_bitop3_b32 v26, v26, v141, v3 bitop3:0xf6
  v_bitop3_b32 v27, v27, v143, v3 bitop3:0xf6
  v_bitop3_b32 v26, v26, v145, v3 bitop3:0xf6
  v_bitop3_b32 v27, v27, v147, v3 bitop3:0xf6
  v_bitop3_b32 v26, v26, v149, v3 bitop3:0xf6
  v_bitop3_b32 v27, v27, v151, v3 bitop3:0xf6
  v_or_b32 v26, v26, v27
  v_cmp_ne_u32 vcc, 0, v26
  s_cbranch_vccz L_gd_105
  v_cmp_ne_u32 vcc, v3, v105
  v_cmp_ne_u32 s[90:91], v3, v107
  s_nop 1
  s_or_b64 vcc, vcc, s[90:91]
  s_and_b64 s[66:67], s[66:67], vcc
  v_cmp_ne_u32 vcc, v3, v109
  v_cmp_ne_u32 s[90:91], v3, v111
  s_nop 1
  s_or_b64 vcc, vcc, s[90:91]
  s_and_b64 s[68:69], s[68:69], vcc
  v_cmp_ne_u32 vcc, v3, v113
  v_cmp_ne_u32 s[90:91], v3, v115
  s_nop 1
  s_or_b64 vcc, vcc, s[90:91]
  s_and_b64 s[70:71], s[70:71], vcc
  v_cmp_ne_u32 vcc, v3, v117
  v_cmp_ne_u32 s[90:91], v3, v119
  s_nop 1
  s_or_b64 vcc, vcc, s[90:91]
  s_and_b64 s[72:73], s[72:73], vcc
  v_cmp_ne_u32 vcc, v3, v121
  v_cmp_ne_u32 s[90:91], v3, v123
  s_nop 1
  s_or_b64 vcc, vcc, s[90:91]
  s_and_b64 s[74:75], s[74:75], vcc
  v_cmp_ne_u32 vcc, v3, v125
  v_cmp_ne_u32 s[90:91], v3, v127
  s_nop 1
  s_or_b64 vcc, vcc, s[90:91]
  s_and_b64 s[76:77], s[76:77], vcc
  v_cmp_ne_u32 vcc, v3, v129
  v_cmp_ne_u32 s[90:91], v3, v131
  s_nop 1
  s_or_b64 vcc, vcc, s[90:91]
  s_and_b64 s[78:79], s[78:79], vcc
  v_cmp_ne_u32 vcc, v3, v133
  v_cmp_ne_u32 s[90:91], v3, v135
  s_nop 1
  s_or_b64 vcc, vcc, s[90:91]
  s_and_b64 s[80:81], s[80:81], vcc
  v_cmp_ne_u32 vcc, v3, v137
  v_cmp_ne_u32 s[90:91], v3, v139
  s_nop 1
  s_or_b64 vcc, vcc, s[90:91]
  s_and_b64 s[82:83], s[82:83], vcc
  v_cmp_ne_u32 vcc, v3, v141
  v_cmp_ne_u32 s[90:91], v3, v143
  s_nop 1
  s_or_b64 vcc, vcc, s[90:91]
  s_and_b64 s[84:85], s[84:85], vcc
  v_cmp_ne_u32 vcc, v3, v145
  v_cmp_ne_u32 s[90:91], v3, v147
  s_nop 1
  s_or_b64 vcc, vcc, s[90:91]
  s_and_b64 s[86:87], s[86:87], vcc
  v_cmp_ne_u32 vcc, v3, v149
  v_cmp_ne_u32 s[90:91], v3, v151
  s_nop 1
  s_or_b64 vcc, vcc, s[90:91]
  s_and_b64 s[88:89], s[88:89], vcc
  s_mov_b64 s[90:91], 0
  s_or_b64 s[90:91], s[90:91], s[66:67]
  s_or_b64 s[90:91], s[90:91], s[68:69]
  s_or_b64 s[90:91], s[90:91], s[70:71]
  s_or_b64 s[90:91], s[90:91], s[72:73]
  s_or_b64 s[90:91], s[90:91], s[74:75]
  s_or_b64 s[90:91], s[90:91], s[76:77]
  s_or_b64 s[90:91], s[90:91], s[78:79]
  s_or_b64 s[90:91], s[90:91], s[80:81]
  s_or_b64 s[90:91], s[90:91], s[82:83]
  s_or_b64 s[90:91], s[90:91], s[84:85]
  s_or_b64 s[90:91], s[90:91], s[86:87]
  s_or_b64 s[90:91], s[90:91], s[88:89]
  s_cbranch_scc0 L_gd_105
  s_sub_u32 s92, s92, 1
  s_cbranch_scc1 L_gd_105
  s_sleep 2
  s_branch L_g_104
L_gd_105:
  s_mov_b64 exec, s[42:43]
  v_lshlrev_b32 v56, 16, v108
  v_and_b32 v57, 0xffff0000, v108
  v_lshlrev_b32 v58, 16, v104
  v_pk_add_f32 v[56:57], v[56:57], v[28:29]
  v_and_b32 v59, 0xffff0000, v104
  v_cvt_pk_bf16_f32 v60, v56, v57
  v_lshlrev_b32 v56, 16, v60
  v_and_b32 v57, 0xffff0000, v60
  v_pk_mul_f32 v[56:57], v[56:57], v[32:33]
  v_cvt_pk_bf16_f32 v60, v56, v57
  v_lshlrev_b32 v56, 16, v60
  v_and_b32 v57, 0xffff0000, v60
  v_pk_add_f32 v[56:57], v[56:57], v[58:59]
  v_cvt_pk_bf16_f32 v68, v56, v57
  v_lshlrev_b32 v62, 16, v110
  v_and_b32 v63, 0xffff0000, v110
  v_lshlrev_b32 v64, 16, v106
  v_pk_add_f32 v[62:63], v[62:63], v[28:29]
  v_and_b32 v65, 0xffff0000, v106
  v_cvt_pk_bf16_f32 v66, v62, v63
  v_lshlrev_b32 v62, 16, v66
  v_and_b32 v63, 0xffff0000, v66
  v_pk_mul_f32 v[62:63], v[62:63], v[34:35]
  v_cvt_pk_bf16_f32 v66, v62, v63
  v_lshlrev_b32 v62, 16, v66
  v_and_b32 v63, 0xffff0000, v66
  v_pk_add_f32 v[62:63], v[62:63], v[64:65]
  v_cvt_pk_bf16_f32 v69, v62, v63
  ds_write_b64 v98, v[68:69]
  v_lshlrev_b32 v56, 16, v116
  v_and_b32 v57, 0xffff0000, v116
  v_lshlrev_b32 v58, 16, v112
  v_pk_add_f32 v[56:57], v[56:57], v[28:29]
  v_and_b32 v59, 0xffff0000, v112
  v_cvt_pk_bf16_f32 v60, v56, v57
  v_lshlrev_b32 v56, 16, v60
  v_and_b32 v57, 0xffff0000, v60
  v_pk_mul_f32 v[56:57], v[56:57], v[36:37]
  v_cvt_pk_bf16_f32 v60, v56, v57
  v_lshlrev_b32 v56, 16, v60
  v_and_b32 v57, 0xffff0000, v60
  v_pk_add_f32 v[56:57], v[56:57], v[58:59]
  v_cvt_pk_bf16_f32 v70, v56, v57
  v_lshlrev_b32 v62, 16, v118
  v_and_b32 v63, 0xffff0000, v118
  v_lshlrev_b32 v64, 16, v114
  v_pk_add_f32 v[62:63], v[62:63], v[28:29]
  v_and_b32 v65, 0xffff0000, v114
  v_cvt_pk_bf16_f32 v66, v62, v63
  v_lshlrev_b32 v62, 16, v66
  v_and_b32 v63, 0xffff0000, v66
  v_pk_mul_f32 v[62:63], v[62:63], v[38:39]
  v_cvt_pk_bf16_f32 v66, v62, v63
  v_lshlrev_b32 v62, 16, v66
  v_and_b32 v63, 0xffff0000, v66
  v_pk_add_f32 v[62:63], v[62:63], v[64:65]
  v_cvt_pk_bf16_f32 v71, v62, v63
  ds_write_b64 v99, v[70:71]
  v_lshlrev_b32 v56, 16, v124
  v_and_b32 v57, 0xffff0000, v124
  v_lshlrev_b32 v58, 16, v120
  v_pk_add_f32 v[56:57], v[56:57], v[28:29]
  v_and_b32 v59, 0xffff0000, v120
  v_cvt_pk_bf16_f32 v60, v56, v57
  v_lshlrev_b32 v56, 16, v60
  v_and_b32 v57, 0xffff0000, v60
  v_pk_mul_f32 v[56:57], v[56:57], v[40:41]
  v_cvt_pk_bf16_f32 v60, v56, v57
  v_lshlrev_b32 v56, 16, v60
  v_and_b32 v57, 0xffff0000, v60
  v_pk_add_f32 v[56:57], v[56:57], v[58:59]
  v_cvt_pk_bf16_f32 v72, v56, v57
  v_lshlrev_b32 v62, 16, v126
  v_and_b32 v63, 0xffff0000, v126
  v_lshlrev_b32 v64, 16, v122
  v_pk_add_f32 v[62:63], v[62:63], v[28:29]
  v_and_b32 v65, 0xffff0000, v122
  v_cvt_pk_bf16_f32 v66, v62, v63
  v_lshlrev_b32 v62, 16, v66
  v_and_b32 v63, 0xffff0000, v66
  v_pk_mul_f32 v[62:63], v[62:63], v[42:43]
  v_cvt_pk_bf16_f32 v66, v62, v63
  v_lshlrev_b32 v62, 16, v66
  v_and_b32 v63, 0xffff0000, v66
  v_pk_add_f32 v[62:63], v[62:63], v[64:65]
  v_cvt_pk_bf16_f32 v73, v62, v63
  ds_write_b64 v100, v[72:73]
  v_lshlrev_b32 v56, 16, v132
  v_and_b32 v57, 0xffff0000, v132
  v_lshlrev_b32 v58, 16, v128
  v_pk_add_f32 v[56:57], v[56:57], v[28:29]
  v_and_b32 v59, 0xffff0000, v128
  v_cvt_pk_bf16_f32 v60, v56, v57
  v_lshlrev_b32 v56, 16, v60
  v_and_b32 v57, 0xffff0000, v60
  v_pk_mul_f32 v[56:57], v[56:57], v[44:45]
  v_cvt_pk_bf16_f32 v60, v56, v57
  v_lshlrev_b32 v56, 16, v60
  v_and_b32 v57, 0xffff0000, v60
  v_pk_add_f32 v[56:57], v[56:57], v[58:59]
  v_cvt_pk_bf16_f32 v74, v56, v57
  v_lshlrev_b32 v62, 16, v134
  v_and_b32 v63, 0xffff0000, v134
  v_lshlrev_b32 v64, 16, v130
  v_pk_add_f32 v[62:63], v[62:63], v[28:29]
  v_and_b32 v65, 0xffff0000, v130
  v_cvt_pk_bf16_f32 v66, v62, v63
  v_lshlrev_b32 v62, 16, v66
  v_and_b32 v63, 0xffff0000, v66
  v_pk_mul_f32 v[62:63], v[62:63], v[46:47]
  v_cvt_pk_bf16_f32 v66, v62, v63
  v_lshlrev_b32 v62, 16, v66
  v_and_b32 v63, 0xffff0000, v66
  v_pk_add_f32 v[62:63], v[62:63], v[64:65]
  v_cvt_pk_bf16_f32 v75, v62, v63
  ds_write_b64 v101, v[74:75]
  v_lshlrev_b32 v56, 16, v140
  v_and_b32 v57, 0xffff0000, v140
  v_lshlrev_b32 v58, 16, v136
  v_pk_add_f32 v[56:57], v[56:57], v[28:29]
  v_and_b32 v59, 0xffff0000, v136
  v_cvt_pk_bf16_f32 v60, v56, v57
  v_lshlrev_b32 v56, 16, v60
  v_and_b32 v57, 0xffff0000, v60
  v_pk_mul_f32 v[56:57], v[56:57], v[48:49]
  v_cvt_pk_bf16_f32 v60, v56, v57
  v_lshlrev_b32 v56, 16, v60
  v_and_b32 v57, 0xffff0000, v60
  v_pk_add_f32 v[56:57], v[56:57], v[58:59]
  v_cvt_pk_bf16_f32 v76, v56, v57
  v_lshlrev_b32 v62, 16, v142
  v_and_b32 v63, 0xffff0000, v142
  v_lshlrev_b32 v64, 16, v138
  v_pk_add_f32 v[62:63], v[62:63], v[28:29]
  v_and_b32 v65, 0xffff0000, v138
  v_cvt_pk_bf16_f32 v66, v62, v63
  v_lshlrev_b32 v62, 16, v66
  v_and_b32 v63, 0xffff0000, v66
  v_pk_mul_f32 v[62:63], v[62:63], v[50:51]
  v_cvt_pk_bf16_f32 v66, v62, v63
  v_lshlrev_b32 v62, 16, v66
  v_and_b32 v63, 0xffff0000, v66
  v_pk_add_f32 v[62:63], v[62:63], v[64:65]
  v_cvt_pk_bf16_f32 v77, v62, v63
  ds_write_b64 v102, v[76:77]
  v_lshlrev_b32 v56, 16, v148
  v_and_b32 v57, 0xffff0000, v148
  v_lshlrev_b32 v58, 16, v144
  v_pk_add_f32 v[56:57], v[56:57], v[28:29]
  v_and_b32 v59, 0xffff0000, v144
  v_cvt_pk_bf16_f32 v60, v56, v57
  v_lshlrev_b32 v56, 16, v60
  v_and_b32 v57, 0xffff0000, v60
  v_pk_mul_f32 v[56:57], v[56:57], v[52:53]
  v_cvt_pk_bf16_f32 v60, v56, v57
  v_lshlrev_b32 v56, 16, v60
  v_and_b32 v57, 0xffff0000, v60
  v_pk_add_f32 v[56:57], v[56:57], v[58:59]
  v_cvt_pk_bf16_f32 v78, v56, v57
  v_lshlrev_b32 v62, 16, v150
  v_and_b32 v63, 0xffff0000, v150
  v_lshlrev_b32 v64, 16, v146
  v_pk_add_f32 v[62:63], v[62:63], v[28:29]
  v_and_b32 v65, 0xffff0000, v146
  v_cvt_pk_bf16_f32 v66, v62, v63
  v_lshlrev_b32 v62, 16, v66
  v_and_b32 v63, 0xffff0000, v66
  v_pk_mul_f32 v[62:63], v[62:63], v[54:55]
  v_cvt_pk_bf16_f32 v66, v62, v63
  v_lshlrev_b32 v62, 16, v66
  v_and_b32 v63, 0xffff0000, v66
  v_pk_add_f32 v[62:63], v[62:63], v[64:65]
  v_cvt_pk_bf16_f32 v79, v62, v63
  ds_write_b64 v103, v[78:79]
  s_waitcnt lgkmcnt(0)
  ds_read_b128 v[32:35], v30 offset:0
  ds_read_b128 v[36:39], v30 offset:64
  ds_read_b128 v[40:43], v30 offset:128
  ds_read_b128 v[44:47], v30 offset:192
  ds_read_b128 v[48:51], v30 offset:256
  ds_read_b128 v[52:55], v30 offset:320
  v_mov_b32 v105, v3
  v_mov_b32 v107, v3
  v_mov_b32 v109, v3
  v_mov_b32 v111, v3
  v_mov_b32 v113, v3
  v_mov_b32 v115, v3
  v_mov_b32 v117, v3
  v_mov_b32 v119, v3
  v_mov_b32 v121, v3
  v_mov_b32 v123, v3
  v_mov_b32 v125, v3
  v_mov_b32 v127, v3
  v_mov_b32 v129, v3
  v_mov_b32 v131, v3
  v_mov_b32 v133, v3
  v_mov_b32 v135, v3
  s_waitcnt lgkmcnt(5)
  v_mfma_f32_16x16x32_bf16 v[64:67], v[32:35], v[160:163], 0
  v_mfma_f32_16x16x32_bf16 v[68:71], v[32:35], v[164:167], 0
  v_mfma_f32_16x16x32_bf16 v[72:75], v[32:35], v[168:171], 0
  v_mfma_f32_16x16x32_bf16 v[76:79], v[32:35], v[172:175], 0
  s_waitcnt lgkmcnt(4)
  v_mfma_f32_16x16x32_bf16 v[64:67], v[36:39], v[176:179], v[64:67]
  v_mfma_f32_16x16x32_bf16 v[68:71], v[36:39], v[180:183], v[68:71]
  v_mfma_f32_16x16x32_bf16 v[72:75], v[36:39], v[184:187], v[72:75]
  v_mfma_f32_16x16x32_bf16 v[76:79], v[36:39], v[188:191], v[76:79]
  s_waitcnt lgkmcnt(3)
  v_mfma_f32_16x16x32_bf16 v[64:67], v[40:43], v[192:195], v[64:67]
  v_mfma_f32_16x16x32_bf16 v[68:71], v[40:43], v[196:199], v[68:71]
  v_mfma_f32_16x16x32_bf16 v[72:75], v[40:43], v[200:203], v[72:75]
  v_mfma_f32_16x16x32_bf16 v[76:79], v[40:43], v[204:207], v[76:79]
  s_waitcnt lgkmcnt(2)
  v_mfma_f32_16x16x32_bf16 v[64:67], v[44:47], v[208:211], v[64:67]
  v_mfma_f32_16x16x32_bf16 v[68:71], v[44:47], v[212:215], v[68:71]
  v_mfma_f32_16x16x32_bf16 v[72:75], v[44:47], v[216:219], v[72:75]
  v_mfma_f32_16x16x32_bf16 v[76:79], v[44:47], v[220:223], v[76:79]
  s_waitcnt lgkmcnt(1)
  v_mfma_f32_16x16x32_bf16 v[64:67], v[48:51], v[224:227], v[64:67]
  v_mfma_f32_16x16x32_bf16 v[68:71], v[48:51], v[228:231], v[68:71]
  v_mfma_f32_16x16x32_bf16 v[72:75], v[48:51], v[232:235], v[72:75]
  v_mfma_f32_16x16x32_bf16 v[76:79], v[48:51], v[236:239], v[76:79]
  s_waitcnt lgkmcnt(0)
  v_mfma_f32_16x16x32_bf16 v[64:67], v[52:55], v[240:243], v[64:67]
  v_mfma_f32_16x16x32_bf16 v[68:71], v[52:55], v[244:247], v[68:71]
  v_mfma_f32_16x16x32_bf16 v[72:75], v[52:55], v[248:251], v[72:75]
  v_mfma_f32_16x16x32_bf16 v[76:79], v[52:55], v[252:255], v[76:79]
  s_nop 4
  v_mov_b32 v104, v64
  v_mov_b32 v106, v65
  v_mov_b32 v108, v66
  v_mov_b32 v110, v67
  v_mov_b32 v112, v68
  v_mov_b32 v114, v69
  v_mov_b32 v116, v70
  v_mov_b32 v118, v71
  v_mov_b32 v120, v72
  v_mov_b32 v122, v73
  v_mov_b32 v124, v74
  v_mov_b32 v126, v75
  v_mov_b32 v128, v76
  v_mov_b32 v130, v77
  v_mov_b32 v132, v78
  v_mov_b32 v134, v79
  s_mov_b32 exec_hi, 0
  s_cbranch_execz L_p2_dry
  buffer_store_dwordx2 v[104:105], v31, s[52:55], s14 offen offset:0 sc1
  buffer_store_dwordx2 v[112:113], v31, s[52:55], s14 offen offset:128 sc1
  buffer_store_dwordx2 v[120:121], v31, s[52:55], s14 offen offset:256 sc1
  buffer_store_dwordx2 v[128:129], v31, s[52:55], s14 offen offset:384 sc1
  s_add_u32 s14, s14, 32768
  buffer_store_dwordx2 v[106:107], v31, s[52:55], s14 offen offset:0 sc1
  buffer_store_dwordx2 v[114:115], v31, s[52:55], s14 offen offset:128 sc1
  buffer_store_dwordx2 v[122:123], v31, s[52:55], s14 offen offset:256 sc1
  buffer_store_dwordx2 v[130:131], v31, s[52:55], s14 offen offset:384 sc1
  s_add_u32 s14, s14, 32768
  buffer_store_dwordx2 v[108:109], v31, s[52:55], s14 offen offset:0 sc1
  buffer_store_dwordx2 v[116:117], v31, s[52:55], s14 offen offset:128 sc1
  buffer_store_dwordx2 v[124:125], v31, s[52:55], s14 offen offset:256 sc1
  buffer_store_dwordx2 v[132:133], v31, s[52:55], s14 offen offset:384 sc1
  s_add_u32 s14, s14, 32768
  buffer_store_dwordx2 v[110:111], v31, s[52:55], s14 offen offset:0 sc1
  buffer_store_dwordx2 v[118:119], v31, s[52:55], s14 offen offset:128 sc1
  buffer_store_dwordx2 v[126:127], v31, s[52:55], s14 offen offset:256 sc1
  buffer_store_dwordx2 v[134:135], v31, s[52:55], s14 offen offset:384 sc1
  s_add_u32 s14, s14, 32768
  s_mov_b64 exec, -1
  v_mov_b32 v14, 160328
  v_mov_b32 v15, 1
  ds_write_b32 v14, v15 offset:16
  s_branch L_join
L_p2_dry:
  s_mov_b64 s[42:43], -1
  s_mov_b64 exec, -1
  s_branch L_p2_go
L_notP2:
  v_mov_b32 v6, 160328
  ds_write_b32 v6, v5
  ds_write_b32 v6, v5 offset:4
  ds_write_b32 v6, v5 offset:8
  ds_write_b32 v6, v5 offset:12
  ds_write_b32 v6, v5 offset:16
  ds_write_b32 v6, v5 offset:20
  s_waitcnt lgkmcnt(0)
  s_barrier
  v_lshrrev_b32 v10, 4, v4
  v_lshlrev_b32 v10, 3, v10
  v_bfe_u32 v11, v4, 2, 2
  v_add_u32 v11, v10, v11
  v_lshlrev_b32 v10, 7, v11
  v_and_b32 v12, 3, v4
  v_lshlrev_b32 v12, 3, v12
  v_add_u32 v10, v10, v12
  v_lshrrev_b32 v24, 5, v4
  v_and_b32 v25, 31, v4
  s_waitcnt vmcnt(0)
  v_add_u32 v3, 2654435769, v3
L_join:
  s_cmp_eq_u32 s3, 3
  s_cbranch_scc0 L_noQ
  s_lshr_b32 s8, s5, 4
  s_lshl_b32 s8, s8, 15
  s_and_b32 s9, s5, 15
  s_lshl_b32 s9, s9, 11
  s_add_u32 s8, s8, s9
  s_add_u32 s13, s8, 131072
  s_add_u32 s14, s13, 0x40000
  s_add_u32 s15, s13, 0x80000
  v_lshlrev_b32 v15, 4, v4
  v_mov_b32 v14, 4096
  s_cmp_lt_u32 s7, 120
  s_cselect_b32 s8, 0, s98
  s_cmp_eq_u32 s8, -1
  s_cbranch_scc1 L_q_mg
  v_mov_b32 v14, 160328
  s_mov_b32 s92, 1200000
L_q_w:
  ds_read_b32 v16, v14 offset:16
  s_waitcnt lgkmcnt(0)
  v_readfirstlane_b32 s8, v16
  s_nop 1
  s_cmp_lg_u32 s8, 0
  s_cbranch_scc1 L_q_go
  s_sub_u32 s92, s92, 1
  s_cbranch_scc1 L_q_go
  s_sleep 2
  s_branch L_q_w
L_q_mg:
  s_and_b32 s90, s42, 0x1
  s_mov_b32 s91, 0
  s_mov_b64 s[66:67], s[90:91]
  s_mov_b32 s92, 300000
L_g_118:
  s_mov_b64 exec, s[66:67]
  s_cbranch_execz L_gs_120
  buffer_load_dwordx2 v[16:17], v14, s[52:55], 0 offen sc1
L_gs_120:
  s_mov_b64 exec, s[42:43]
  s_waitcnt vmcnt(0)
  v_cmp_ne_u32 vcc, v3, v17
  s_nop 1
  s_and_b64 s[66:67], s[66:67], vcc
  s_mov_b64 s[90:91], 0
  s_or_b64 s[90:91], s[90:91], s[66:67]
  s_cbranch_scc0 L_gd_119
  s_sub_u32 s92, s92, 1
  s_cbranch_scc1 L_gd_119
  s_sleep 4
  s_branch L_g_118
L_gd_119:
  s_mov_b64 exec, s[42:43]
L_q_go:
  s_mov_b64 s[66:67], s[42:43]
  s_mov_b64 s[68:69], s[42:43]
  s_mov_b64 s[70:71], s[42:43]
  s_mov_b64 s[72:73], s[42:43]
  s_mov_b64 s[74:75], s[42:43]
  s_mov_b64 s[76:77], s[42:43]
  s_mov_b32 s92, 300000
L_g_121:
  s_mov_b64 exec, s[66:67]
  s_cbranch_execz L_gs_123
  buffer_load_dwordx4 v[32:35], v15, s[52:55], s13 offen offset:0 sc1
L_gs_123:
  s_mov_b64 exec, s[68:69]
  s_cbranch_execz L_gs_124
  buffer_load_dwordx4 v[36:39], v15, s[52:55], s13 offen offset:1024 sc1
L_gs_124:
  s_mov_b64 exec, s[70:71]
  s_cbranch_execz L_gs_125
  buffer_load_dwordx4 v[40:43], v15, s[52:55], s14 offen offset:0 sc1
L_gs_125:
  s_mov_b64 exec, s[72:73]
  s_cbranch_execz L_gs_126
  buffer_load_dwordx4 v[44:47], v15, s[52:55], s14 offen offset:1024 sc1
L_gs_126:
  s_mov_b64 exec, s[74:75]
  s_cbranch_execz L_gs_127
  buffer_load_dwordx4 v[48:51], v15, s[52:55], s15 offen offset:0 sc1
L_gs_127:
  s_mov_b64 exec, s[76:77]
  s_cbranch_execz L_gs_128
  buffer_load_dwordx4 v[52:55], v15, s[52:55], s15 offen offset:1024 sc1
L_gs_128:
  s_mov_b64 exec, s[42:43]
  s_waitcnt vmcnt(0)
  v_xor_b32 v26, v3, v33
  v_xor_b32 v27, v3, v35
  v_bitop3_b32 v26, v26, v37, v3 bitop3:0xf6
  v_bitop3_b32 v27, v27, v39, v3 bitop3:0xf6
  v_bitop3_b32 v26, v26, v41, v3 bitop3:0xf6
  v_bitop3_b32 v27, v27, v43, v3 bitop3:0xf6
  v_bitop3_b32 v26, v26, v45, v3 bitop3:0xf6
  v_bitop3_b32 v27, v27, v47, v3 bitop3:0xf6
  v_bitop3_b32 v26, v26, v49, v3 bitop3:0xf6
  v_bitop3_b32 v27, v27, v51, v3 bitop3:0xf6
  v_bitop3_b32 v26, v26, v53, v3 bitop3:0xf6
  v_bitop3_b32 v27, v27, v55, v3 bitop3:0xf6
  v_or_b32 v26, v26, v27
  v_cmp_ne_u32 vcc, 0, v26
  s_cbranch_vccz L_gd_122
  v_cmp_ne_u32 vcc, v3, v33
  v_cmp_ne_u32 s[90:91], v3, v35
  s_nop 1
  s_or_b64 vcc, vcc, s[90:91]
  s_and_b64 s[66:67], s[66:67], vcc
  v_cmp_ne_u32 vcc, v3, v37
  v_cmp_ne_u32 s[90:91], v3, v39
  s_nop 1
  s_or_b64 vcc, vcc, s[90:91]
  s_and_b64 s[68:69], s[68:69], vcc
  v_cmp_ne_u32 vcc, v3, v41
  v_cmp_ne_u32 s[90:91], v3, v43
  s_nop 1
  s_or_b64 vcc, vcc, s[90:91]
  s_and_b64 s[70:71], s[70:71], vcc
  v_cmp_ne_u32 vcc, v3, v45
  v_cmp_ne_u32 s[90:91], v3, v47
  s_nop 1
  s_or_b64 vcc, vcc, s[90:91]
  s_and_b64 s[72:73], s[72:73], vcc
  v_cmp_ne_u32 vcc, v3, v49
  v_cmp_ne_u32 s[90:91], v3, v51
  s_nop 1
  s_or_b64 vcc, vcc, s[90:91]
  s_and_b64 s[74:75], s[74:75], vcc
  v_cmp_ne_u32 vcc, v3, v53
  v_cmp_ne_u32 s[90:91], v3, v55
  s_nop 1
  s_or_b64 vcc, vcc, s[90:91]
  s_and_b64 s[76:77], s[76:77], vcc
  s_mov_b64 s[90:91], 0
  s_or_b64 s[90:91], s[90:91], s[66:67]
  s_or_b64 s[90:91], s[90:91], s[68:69]
  s_or_b64 s[90:91], s[90:91], s[70:71]
  s_or_b64 s[90:91], s[90:91], s[72:73]
  s_or_b64 s[90:91], s[90:91], s[74:75]
  s_or_b64 s[90:91], s[90:91], s[76:77]
  s_cbranch_scc0 L_gd_122
  s_sub_u32 s92, s92, 1
  s_cbranch_scc1 L_gd_122
  s_sleep 10
  s_branch L_g_121
L_gd_122:
  s_mov_b64 exec, s[42:43]
  v_add_f32 v32, v32, v40
  v_add_f32 v32, v32, v48
  v_add_f32 v34, v34, v42
  v_add_f32 v34, v34, v50
  v_cvt_pk_bf16_f32 v32, v32, v34
  v_add_f32 v36, v36, v44
  v_add_f32 v36, v36, v52
  v_add_f32 v38, v38, v46
  v_add_f32 v38, v38, v54
  v_cvt_pk_bf16_f32 v36, v36, v38
  v_lshlrev_b32 v14, 2, v4
  v_add_u32 v14, 159744, v14
  ds_write_b32 v14, v32
  ds_write_b32 v14, v36 offset:256
  v_mov_b32 v14, 160256
  ds_write_b32 v14, v3
  v_mov_b32 v16, 0
  v_mov_b32 v17, 0
  ds_write_b64 v14, v[16:17] offset:128
  ds_write_b64 v14, v[16:17] offset:136
  v_mov_b32 v16, 1
  s_waitcnt lgkmcnt(0)
  ds_write_b32 v14, v16 offset:72
L_noQ:
  v_mov_b32 v26, 0
  v_mov_b32 v27, 0
  v_mov_b32 v28, 0
  v_mov_b32 v29, 0
  v_mov_b32 v30, 0
  v_mov_b32 v31, 0
  v_mov_b32 v32, 0
  v_mov_b32 v33, 0
  v_mov_b32 v34, 0
  v_mov_b32 v35, 0
  v_mov_b32 v36, 0
  v_mov_b32 v96, 0
  v_mov_b32 v97, 0
  v_mov_b32 v98, 0
  v_mov_b32 v99, 0
  v_mov_b32 v100, 0
  v_mov_b32 v101, 0
  v_mov_b32 v102, 0
  v_mov_b32 v103, 0
  v_mov_b32 v144, 0
  v_mov_b32 v145, 0
  v_mov_b32 v146, 0
  v_mov_b32 v147, 0
  v_mov_b32 v148, 0
  v_mov_b32 v149, 0
  v_mov_b32 v150, 0
  v_mov_b32 v151, 0
  s_mov_b32 s60, s36
  s_mov_b32 s61, s37
  s_mov_b32 s62, 9216
  s_mov_b32 s63, 0x20000
  s_mov_b32 s44, s28
  s_mov_b32 s45, s29
  s_mov_b32 s46, 5308416
  s_mov_b32 s47, 0x20000
  v_mov_b32 v6, 160328
  s_cmp_lt_u32 s7, 128
  s_cselect_b32 s99, 0, 73728
  s_lshl_b32 s8, s3, 13
  s_add_u32 s99, s99, s8
  s_mul_i32 s8, s95, 57
  s_lshr_b32 s8, s8, 9
  s_mul_i32 s9, s8, 9
  s_sub_u32 s9, s95, s9
  s_lshl_b32 s8, s8, 8
  s_lshl_b32 s10, s3, 6
  s_add_u32 s8, s8, s10
  s_mul_i32 s8, s8, 1152
  s_lshl_b32 s9, s9, 7
  s_add_u32 s16, s8, s9
  s_mov_b32 s17, s99
  s_cmp_eq_u32 s95, -1
  s_cselect_b32 s8, 0, 8192
  s_add_u32 s18, s17, s8
  s_mov_b32 s19, 9216
  v_mul_u32_u24 v1, 1152, v8
  v_add_u32 v1, v1, v9
  s_cmp_eq_u32 s98, -1
  s_cbranch_scc0 L_dM
  s_mov_b32 s44, s24
  s_mov_b32 s45, s25
  s_mov_b32 s46, 4718592
  s_mov_b32 s47, 0x20000
  s_branch L_dgo
L_dM:
  v_mul_u32_u24 v1, 9216, v8
  v_add_u32 v1, v1, v9
  s_mul_i32 s8, s3, 1327104
  s_lshl_b32 s9, s98, 7
  s_add_u32 s16, s8, s9
  s_mul_i32 s17, s3, 18432
  s_add_u32 s18, s17, 18432
  s_mov_b32 s19, 73728
L_dgo:
  s_mov_b32 s48, s30
  s_mov_b32 s49, s31
  s_mov_b32 s50, 5308416
  s_mov_b32 s51, 0x20000
  s_mov_b32 s92, 1200000
L_lw_129:
  ds_read_b64 v[16:17], v6
  s_waitcnt lgkmcnt(0)
  v_or_b32 v16, v16, v17
  s_nop 0
  v_readfirstlane_b32 s11, v16
  s_nop 1
  s_cmp_lg_u32 s11, 0
  s_cbranch_scc1 L_lwd_130
  s_sub_u32 s92, s92, 1
  s_cbranch_scc1 L_lwd_130
  s_sleep 4
  s_branch L_lw_129
L_lwd_130:
L_dlp:
  s_cmp_lt_u32 s17, s18
  s_cbranch_scc0 L_dend
  ds_read_b32 v16, v6
  s_waitcnt vmcnt(7) lgkmcnt(0)
  v_readfirstlane_b32 s11, v16
  s_nop 1
  s_cmp_eq_u32 s11, 0
  s_cbranch_scc1 L_dfast
  s_cmp_eq_u32 s98, -1
  s_branch L_dend
  s_waitcnt vmcnt(2)
L_dfast:
  s_mov_b32 m0, s17
  s_add_u32 s17, s17, 1024
  buffer_load_dwordx4 v1, s[44:47], s16 offen nt lds
  s_add_u32 s16, s16, s19
  s_branch L_dlp
L_dend:
  s_cmp_eq_u32 s3, 0
  s_cselect_b32 s8, s7, -1
  s_cmp_lt_u32 s7, 72
  s_cselect_b32 s96, s8, -1
  s_add_u32 s8, s7, 184
  s_cmp_lt_u32 s7, 104
  s_cselect_b32 s8, s8, -1
  s_cmp_eq_u32 s3, 2
  s_cselect_b32 s97, s8, -1
  s_cmp_eq_u32 s3, 1
  s_cselect_b32 s97, s7, s97
  s_cmp_eq_u32 s98, -1
  s_cselect_b32 s97, s97, -1
  s_lshl_b32 s8, s3, 8
  s_add_u32 s8, s8, 148480
  v_lshlrev_b32 v2, 2, v4
  v_add_u32 v2, s8, v2
  v_lshlrev_b32 v13, 3, v4
  s_lshl_b32 s26, s4, 11
  s_lshl_b32 s9, s3, 9
  s_add_u32 s26, s26, s9
  s_add_u32 s26, s26, 1048576
  v_mov_b32 v21, v3
  v_mov_b32 v36, v3
  v_lshrrev_b32 v37, 8, v3
  v_lshrrev_b32 v38, 16, v3
  v_lshrrev_b32 v39, 24, v3
  s_mov_b32 s64, 0x0c0c0400
  s_mov_b32 s65, 0x04000c0c
  s_cmp_eq_u32 s96, -1
  s_cbranch_scc1 L_noB1a
  s_mul_i32 s8, s96, 57
  s_lshr_b32 s8, s8, 9
  s_mul_i32 s9, s8, 9
  s_sub_u32 s9, s96, s9
  s_mul_i32 s10, s8, 1152
  s_lshl_b32 s11, s9, 7
  s_add_u32 s10, s10, s11
  v_and_b32 v16, 15, v4
  v_lshrrev_b32 v17, 4, v4
  v_lshl_add_u32 v31, v16, 1, v24
  v_lshlrev_b32 v14, 2, v31
  v_lshlrev_b32 v31, 3, v31
  buffer_load_dword v30, v14, s[56:59], s10 offen
  s_mul_i32 s13, s8, 13824
  s_lshl_b32 s11, s9, 8
  s_add_u32 s13, s13, s11
  s_add_u32 s13, s13, 8704
  s_mul_i32 s38, s8, 2304
  s_add_u32 s38, s38, s11
  s_add_u32 s38, s38, 2228224
  s_lshl_b32 s10, s9, 11
  s_lshl_b32 s11, s8, 8
  s_add_u32 s10, s10, s11
  s_add_u32 s10, s10, 1572864
  v_mul_u32_u24 v14, 18432, v17
  v_lshlrev_b32 v15, 4, v16
  v_add3_u32 v14, v14, v15, s10
  v_add_u32 v144, 0, v14
  v_add_u32 v145, 73728, v14
  v_add_u32 v146, 147456, v14
  v_add_u32 v147, 221184, v14
  s_mov_b64 s[66:67], s[42:43]
  s_mov_b32 s92, 300000
L_g_131:
  s_mov_b64 exec, s[66:67]
  s_cbranch_execz L_gs_133
  buffer_load_dwordx2 v[32:33], v31, s[52:55], s13 offen sc1
L_gs_133:
  s_mov_b64 exec, s[42:43]
  s_waitcnt vmcnt(0)
  v_cmp_ne_u32 vcc, v3, v33
  s_nop 1
  s_and_b64 s[66:67], s[66:67], vcc
  s_mov_b64 s[90:91], 0
  s_or_b64 s[90:91], s[90:91], s[66:67]
  s_cbranch_scc0 L_gd_132
  s_sub_u32 s92, s92, 1
  s_cbranch_scc1 L_gd_132
  s_sleep 4
  s_branch L_g_131
L_gd_132:
  s_mov_b64 exec, s[42:43]
  v_and_b32 v14, 16, v4
  v_cmp_eq_u32 vcc, 0, v14
  v_lshlrev_b32 v16, 16, v32
  v_and_b32 v17, 0xffff0000, v32
  v_lshlrev_b32 v18, 16, v30
  v_and_b32 v19, 0xffff0000, v30
  v_cndmask_b32 v26, v17, v16, vcc
  v_cndmask_b32 v28, v19, v18, vcc
L_noB1a:
  s_cmp_eq_u32 s97, -1
  s_cbranch_scc1 L_noDa
  s_lshr_b32 s8, s97, 3
  s_lshl_b32 s8, s8, 4
  s_and_b32 s9, s97, 3
  s_lshl_b32 s9, s9, 2
  s_add_u32 s8, s8, s9
  v_and_b32 v29, 3, v4
  v_add_u32 v29, s8, v29
  s_bfe_u32 s9, s97, 0x10002
  s_lshl_b32 s9, s9, 2
  v_bfe_u32 v30, v4, 2, 2
  v_add_u32 v30, s9, v30
  v_lshrrev_b32 v14, 1, v29
  v_lshlrev_b32 v14, 3, v14
  v_mul_u32_u24 v15, 13824, v30
  v_add_u32 v15, v15, v14
  v_mul_u32_u24 v27, 2304, v30
  v_add_u32 v27, v27, v14
  s_and_b32 s10, s97, 0
  s_mul_i32 s10, s10, 18432
  s_add_u32 s10, s10, 2228224
  v_add_u32 v27, s10, v27
  v_mul_u32_u24 v28, 1152, v30
  v_lshl_add_u32 v28, v29, 1, v28
  s_mov_b32 s13, 15616
  s_lshl_b32 s8, s97, 6
  s_add_u32 s8, s8, 2424832
  v_lshrrev_b32 v14, 2, v4
  v_mul_u32_u24 v14, 18432, v14
  v_and_b32 v16, 3, v4
  v_lshlrev_b32 v16, 4, v16
  v_add3_u32 v14, v14, v16, s8
  v_add_u32 v144, 0, v14
  v_add_u32 v145, 294912, v14
  v_add_u32 v146, 589824, v14
  v_add_u32 v147, 884736, v14
  v_add_u32 v148, 1179648, v14
  s_mov_b64 s[66:67], s[42:43]
  s_mov_b32 s92, 300000
L_g_134:
  s_mov_b64 exec, s[66:67]
  s_cbranch_execz L_gs_136
  buffer_load_dwordx2 v[32:33], v15, s[52:55], s13 offen sc1
L_gs_136:
  s_mov_b64 exec, s[42:43]
  s_waitcnt vmcnt(0)
  v_cmp_ne_u32 vcc, v3, v33
  s_nop 1
  s_and_b64 s[66:67], s[66:67], vcc
  s_mov_b64 s[90:91], 0
  s_or_b64 s[90:91], s[90:91], s[66:67]
  s_cbranch_scc0 L_gd_135
  s_sub_u32 s92, s92, 1
  s_cbranch_scc1 L_gd_135
  s_sleep 4
  s_branch L_g_134
L_gd_135:
  s_mov_b64 exec, s[42:43]
  v_and_b32 v29, 1, v29
  v_cmp_eq_u32 vcc, 0, v29
  v_lshlrev_b32 v16, 16, v32
  v_and_b32 v17, 0xffff0000, v32
  v_cndmask_b32 v26, v17, v16, vcc
L_noDa:
  s_cmp_eq_u32 s98, -1
  s_cbranch_scc1 L_noMb
  s_mov_b32 s94, s3
  v_and_b32 v15, 7, v4
  v_lshrrev_b32 v16, 4, v4
  v_lshlrev_b32 v16, 4, v16
  v_mul_u32_u24 v28, 1184, v15
  v_add_u32 v28, v28, v16
  v_add_u32 v28, 147456, v28
  v_bfe_u32 v17, v4, 3, 1
  v_lshl_add_u32 v9, v17, 6, v28
  v_lshl_add_u32 v28, v17, 9, v28
  v_mul_u32_u24 v29, 160, v15
  v_add_u32 v29, v29, v16
  v_add_u32 v29, 156928, v29
  v_bfe_u32 v30, v4, 4, 1
  v_mul_u32_u24 v30, 640, v30
  v_and_b32 v17, 15, v4
  v_lshlrev_b32 v17, 1, v17
  s_lshl_b32 s8, s3, 5
  s_add_u32 s8, s8, 156928
  v_add3_u32 v30, v30, v17, s8
  v_and_b32 v15, 8, v4
  v_cmp_eq_u32 vcc, 0, v15
  v_mov_b32 v16, 160384
  v_mov_b32 v17, 160320
  v_cndmask_b32 v31, v16, v29, vcc
  v_cndmask_b32 v32, v29, v16, vcc
  v_cndmask_b32 v33, v17, v29, vcc
  v_cndmask_b32 v34, v29, v17, vcc
  v_lshlrev_b32 v35, 4, v4
  s_mul_i32 s39, s98, 18432
  s_mul_i32 s9, s3, 4608
  s_add_u32 s39, s39, s9
  s_add_u32 s39, s39, 2424832
  s_nop 0
  s_mul_i32 s13, s94, 13824
  s_add_u32 s14, s13, 13312
  s_add_u32 s13, s13, 11008
  v_lshlrev_b32 v6, 3, v4
  s_mul_i32 s8, s94, 2304
  s_add_u32 s8, s8, 2228224
  v_add_u32 v26, s8, v6
  s_mul_i32 s8, s94, 1184
  s_add_u32 s8, s8, 147456
  v_lshlrev_b32 v27, 2, v4
  v_add_u32 v27, s8, v27
  s_mov_b64 s[66:67], s[42:43]
  s_mov_b64 s[68:69], s[42:43]
  s_mov_b64 s[70:71], s[42:43]
  s_mov_b64 s[72:73], s[42:43]
  s_mov_b32 s74, s42
  s_mov_b32 s75, 0
  s_mov_b64 s[76:77], s[42:43]
  s_mov_b64 s[78:79], s[42:43]
  s_mov_b64 s[80:81], s[42:43]
  s_mov_b64 s[82:83], s[42:43]
  s_mov_b32 s84, s42
  s_mov_b32 s85, 0
  s_mov_b32 s92, 300000
L_g_137:
  s_mov_b64 exec, s[66:67]
  s_cbranch_execz L_gs_139
  buffer_load_dwordx2 v[76:77], v6, s[52:55], s13 offen offset:0 sc1
L_gs_139:
  s_mov_b64 exec, s[68:69]
  s_cbranch_execz L_gs_140
  buffer_load_dwordx2 v[78:79], v6, s[52:55], s13 offen offset:512 sc1
L_gs_140:
  s_mov_b64 exec, s[70:71]
  s_cbranch_execz L_gs_141
  buffer_load_dwordx2 v[80:81], v6, s[52:55], s13 offen offset:1024 sc1
L_gs_141:
  s_mov_b64 exec, s[72:73]
  s_cbranch_execz L_gs_142
  buffer_load_dwordx2 v[82:83], v6, s[52:55], s13 offen offset:1536 sc1
L_gs_142:
  s_mov_b64 exec, s[74:75]
  s_cbranch_execz L_gs_143
  buffer_load_dwordx2 v[84:85], v6, s[52:55], s13 offen offset:2048 sc1
L_gs_143:
  s_mov_b64 exec, s[76:77]
  s_cbranch_execz L_gs_144
  buffer_load_dwordx2 v[86:87], v6, s[52:55], s14 offen offset:0 sc1
L_gs_144:
  s_mov_b64 exec, s[78:79]
  s_cbranch_execz L_gs_145
  buffer_load_dwordx2 v[88:89], v6, s[52:55], s14 offen offset:512 sc1
L_gs_145:
  s_mov_b64 exec, s[80:81]
  s_cbranch_execz L_gs_146
  buffer_load_dwordx2 v[90:91], v6, s[52:55], s14 offen offset:1024 sc1
L_gs_146:
  s_mov_b64 exec, s[82:83]
  s_cbranch_execz L_gs_147
  buffer_load_dwordx2 v[92:93], v6, s[52:55], s14 offen offset:1536 sc1
L_gs_147:
  s_mov_b64 exec, s[84:85]
  s_cbranch_execz L_gs_148
  buffer_load_dwordx2 v[94:95], v6, s[52:55], s14 offen offset:2048 sc1
L_gs_148:
  s_mov_b64 exec, s[42:43]
  s_waitcnt vmcnt(0)
  v_cmp_ne_u32 vcc, v3, v77
  s_nop 1
  s_and_b64 s[66:67], s[66:67], vcc
  v_cmp_ne_u32 vcc, v3, v79
  s_nop 1
  s_and_b64 s[68:69], s[68:69], vcc
  v_cmp_ne_u32 vcc, v3, v81
  s_nop 1
  s_and_b64 s[70:71], s[70:71], vcc
  v_cmp_ne_u32 vcc, v3, v83
  s_nop 1
  s_and_b64 s[72:73], s[72:73], vcc
  v_cmp_ne_u32 vcc, v3, v85
  s_nop 1
  s_and_b64 s[74:75], s[74:75], vcc
  v_cmp_ne_u32 vcc, v3, v87
  s_nop 1
  s_and_b64 s[76:77], s[76:77], vcc
  v_cmp_ne_u32 vcc, v3, v89
  s_nop 1
  s_and_b64 s[78:79], s[78:79], vcc
  v_cmp_ne_u32 vcc, v3, v91
  s_nop 1
  s_and_b64 s[80:81], s[80:81], vcc
  v_cmp_ne_u32 vcc, v3, v93
  s_nop 1
  s_and_b64 s[82:83], s[82:83], vcc
  v_cmp_ne_u32 vcc, v3, v95
  s_nop 1
  s_and_b64 s[84:85], s[84:85], vcc
  s_mov_b64 s[90:91], 0
  s_or_b64 s[90:91], s[90:91], s[66:67]
  s_or_b64 s[90:91], s[90:91], s[68:69]
  s_or_b64 s[90:91], s[90:91], s[70:71]
  s_or_b64 s[90:91], s[90:91], s[72:73]
  s_or_b64 s[90:91], s[90:91], s[74:75]
  s_or_b64 s[90:91], s[90:91], s[76:77]
  s_or_b64 s[90:91], s[90:91], s[78:79]
  s_or_b64 s[90:91], s[90:91], s[80:81]
  s_or_b64 s[90:91], s[90:91], s[82:83]
  s_or_b64 s[90:91], s[90:91], s[84:85]
  s_cbranch_scc0 L_gd_138
  s_sub_u32 s92, s92, 1
  s_cbranch_scc1 L_gd_138
  s_sleep 4
  s_branch L_g_137
L_gd_138:
  s_mov_b64 exec, s[42:43]
  v_lshlrev_b32 v40, 16, v76
  v_and_b32 v41, 0xffff0000, v76
  v_lshlrev_b32 v42, 16, v78
  v_and_b32 v43, 0xffff0000, v78
  v_lshlrev_b32 v44, 16, v80
  v_and_b32 v45, 0xffff0000, v80
  v_lshlrev_b32 v46, 16, v82
  v_and_b32 v47, 0xffff0000, v82
  v_lshlrev_b32 v48, 16, v84
  v_and_b32 v49, 0xffff0000, v84
  v_lshlrev_b32 v18, 16, v86
  v_and_b32 v19, 0xffff0000, v86
  v_add_f32 v18, 1.0, v18
  v_add_f32 v19, 1.0, v19
  v_cvt_pk_bf16_f32 v22, v18, v19
  v_lshlrev_b32 v58, 16, v22
  v_and_b32 v59, 0xffff0000, v22
  v_lshlrev_b32 v18, 16, v88
  v_and_b32 v19, 0xffff0000, v88
  v_add_f32 v18, 1.0, v18
  v_add_f32 v19, 1.0, v19
  v_cvt_pk_bf16_f32 v22, v18, v19
  v_lshlrev_b32 v60, 16, v22
  v_and_b32 v61, 0xffff0000, v22
  v_lshlrev_b32 v18, 16, v90
  v_and_b32 v19, 0xffff0000, v90
  v_add_f32 v18, 1.0, v18
  v_add_f32 v19, 1.0, v19
  v_cvt_pk_bf16_f32 v22, v18, v19
  v_lshlrev_b32 v62, 16, v22
  v_and_b32 v63, 0xffff0000, v22
  v_lshlrev_b32 v18, 16, v92
  v_and_b32 v19, 0xffff0000, v92
  v_add_f32 v18, 1.0, v18
  v_add_f32 v19, 1.0, v19
  v_cvt_pk_bf16_f32 v22, v18, v19
  v_lshlrev_b32 v64, 16, v22
  v_and_b32 v65, 0xffff0000, v22
  v_lshlrev_b32 v18, 16, v94
  v_and_b32 v19, 0xffff0000, v94
  v_add_f32 v18, 1.0, v18
  v_add_f32 v19, 1.0, v19
  v_cvt_pk_bf16_f32 v22, v18, v19
  v_lshlrev_b32 v66, 16, v22
  v_and_b32 v67, 0xffff0000, v22
  v_mov_b32 v84, 0
L_noMb:
  s_waitcnt vmcnt(0)
  s_cmp_eq_u32 s95, -1
  s_cbranch_scc1 L_noWOb
  s_mul_i32 s12, s95, 57
  s_lshr_b32 s12, s12, 9
  s_lshl_b32 s8, s12, 12
  s_lshl_b32 s9, s3, 9
  s_add_u32 s8, s8, s9
  s_add_u32 s8, s8, 1048576
  v_lshlrev_b32 v14, 11, v24
  v_lshlrev_b32 v15, 4, v25
  v_add3_u32 v14, v14, v15, s8
  v_add_u32 v96, 0, v14
  v_add_u32 v97, 65536, v14
  v_add_u32 v98, 131072, v14
  v_add_u32 v99, 196608, v14
  v_add_u32 v100, 262144, v14
  v_add_u32 v101, 327680, v14
  v_add_u32 v102, 393216, v14
  v_add_u32 v103, 458752, v14
  s_mul_i32 s8, s3, 1280
  s_add_u32 s8, s8, 134144
  v_mul_u32_u24 v32, 160, v24
  v_lshlrev_b32 v15, 2, v25
  v_add3_u32 v32, v32, v15, s8
  v_and_b32 v40, 7, v4
  v_mul_u32_u24 v40, 160, v40
  v_lshrrev_b32 v15, 4, v4
  v_lshlrev_b32 v15, 4, v15
  v_add3_u32 v40, v40, v15, s8
  v_bfe_u32 v34, v4, 4, 1
  v_lshlrev_b32 v34, 10, v34
  v_and_b32 v15, 15, v4
  v_lshlrev_b32 v15, 2, v15
  s_lshl_b32 s8, s3, 11
  s_add_u32 s8, s8, 139776
  v_add3_u32 v34, v34, v15, s8
  s_lshl_b32 s8, s3, 9
  s_add_u32 s27, s8, 1572864
  s_add_u32 s8, s8, 139776
  v_lshlrev_b32 v33, 4, v25
  v_add_u32 v35, s8, v33
  s_lshl_b32 s9, s95, 11
  s_add_u32 s27, s27, s9
  s_waitcnt lgkmcnt(0)
L_noWOb:
  s_mov_b64 s[42:43], 0
  s_mov_b64 exec, 0
  s_branch L_tail
L_be:
  s_cmp_eq_u32 s3, 3
  s_cbranch_scc0 L_nosvc
  v_mov_b32 v14, 160328
  v_and_b32 v15, 3, v4
  v_lshlrev_b32 v15, 4, v15
  v_lshlrev_b32 v16, 3, v24
  v_add_u32 v15, v15, v16
  v_add_u32 v15, 160416, v15
  v_lshlrev_b32 v22, 4, v24
  s_lshl_b32 s13, s4, 7
  s_add_u32 s13, s13, 917504
  s_xor_b32 s14, s13, 128
  s_mov_b32 s12, 1069066811
  s_mov_b32 s92, 1200000
L_svc_w:
  ds_read_b32 v16, v14 offset:8
  s_waitcnt lgkmcnt(0)
  v_readfirstlane_b32 s8, v16
  s_nop 1
  s_cmp_eq_u32 s8, 4
  s_cbranch_scc1 L_svc_go
  s_sub_u32 s92, s92, 1
  s_cbranch_scc1 L_svc_go
  s_sleep 2
  s_branch L_svc_w
L_svc_go:
  ds_read_b64 v[18:19], v15
  s_waitcnt lgkmcnt(0)
  v_max_f32_dpp v16, v18, v18 quad_perm:[1,0,3,2] row_mask:0xf bank_mask:0xf
  s_nop 1
  v_max_f32_dpp v16, v16, v16 quad_perm:[2,3,0,1] row_mask:0xf bank_mask:0xf
  v_sub_f32 v18, v18, v16
  v_mul_f32 v18, s12, v18
  v_exp_f32 v18, v18
  s_nop 0
  v_mul_f32 v18, v18, v19
  s_nop 1
  v_add_f32_dpp v18, v18, v18 quad_perm:[1,0,3,2] row_mask:0xf bank_mask:0xf
  s_nop 1
  v_add_f32_dpp v18, v18, v18 quad_perm:[2,3,0,1] row_mask:0xf bank_mask:0xf
  v_mov_b32 v17, v3
  v_mov_b32 v19, v3
  s_mov_b32 exec_lo, 1
  s_mov_b32 exec_hi, 1
  buffer_store_dwordx4 v[16:19], v22, s[52:55], s13 offen sc1
  s_mov_b64 exec, -1
  s_mov_b64 s[66:67], s[42:43]
  s_mov_b32 s92, 300000
L_g_149:
  s_mov_b64 exec, s[66:67]
  s_cbranch_execz L_gs_151
  buffer_load_dwordx4 v[152:155], v22, s[52:55], s14 offen sc1
L_gs_151:
  s_mov_b64 exec, s[42:43]
  s_waitcnt vmcnt(0)
  v_cmp_ne_u32 vcc, v3, v153
  v_cmp_ne_u32 s[90:91], v3, v155
  s_nop 1
  s_or_b64 vcc, vcc, s[90:91]
  s_and_b64 s[66:67], s[66:67], vcc
  s_mov_b64 s[90:91], 0
  s_or_b64 s[90:91], s[90:91], s[66:67]
  s_cbranch_scc0 L_gd_150
  s_sub_u32 s92, s92, 1
  s_cbranch_scc1 L_gd_150
  s_sleep 4
  s_branch L_g_149
L_gd_150:
  s_mov_b64 exec, s[42:43]
  s_cmp_eq_u32 s92, 300000
  s_cselect_b32 s15, 2, 1
  v_max_f32 v156, v16, v152
  v_sub_f32 v16, v16, v156
  v_sub_f32 v152, v152, v156
  v_mul_f32 v16, s12, v16
  v_mul_f32 v152, s12, v152
  v_exp_f32 v16, v16
  v_exp_f32 v152, v152
  v_mul_f32 v18, v18, v16
  v_fmac_f32 v18, v152, v154
  v_rcp_f32 v157, v18
  s_nop 0
  v_fma_f32 v16, -v18, v157, 1.0
  v_fma_f32 v157, v16, v157, v157
  v_lshlrev_b32 v15, 3, v24
  v_add_u32 v15, 160480, v15
  ds_write_b64 v15, v[156:157]
  v_mov_b32 v16, s15
  s_waitcnt lgkmcnt(0)
  ds_write_b32 v14, v16 offset:12
  s_waitcnt lgkmcnt(0)
L_nosvc:
  v_mov_b32 v14, 160328
  s_mov_b32 s92, 1200000
L_ne_w:
  ds_read_b32 v16, v14 offset:20
  s_waitcnt lgkmcnt(0)
  v_readfirstlane_b32 s8, v16
  s_nop 1
  s_cmp_lg_u32 s8, 0
  s_cbranch_scc1 L_ne_go
  s_sub_u32 s92, s92, 1
  s_cbranch_scc1 L_ne_go
  s_sleep 8
  s_branch L_ne_w
L_ne_go:
  s_cmp_eq_u32 s98, -1
  s_cselect_b32 s8, 8, 0
  s_lshl_b32 s8, s8, 10
  s_add_u32 s8, s17, s8
  s_min_u32 s8, s8, s18
L_ne_l:
  s_cmp_lt_u32 s17, s8
  s_cbranch_scc0 L_ne_e
  s_waitcnt vmcnt(3)
  s_mov_b32 m0, s17
  s_add_u32 s17, s17, 1024
  buffer_load_dwordx4 v1, s[44:47], s16 offen nt lds
  s_add_u32 s16, s16, s19
  s_branch L_ne_l
L_ne_e:
  s_barrier
L_tail:
  ds_read_b32 v16, v2
  ds_read_b32 v17, v2 offset:3072
  ds_read_b32 v18, v2 offset:6144
  ds_read_b32 v19, v2 offset:9216
  s_mov_b32 s9, 0xff
  s_waitcnt lgkmcnt(0)
  v_add_f32 v16, v16, v17
  v_add_f32 v18, v18, v19
  v_add_f32 v20, v16, v18
  s_cbranch_execz L_k_152
  buffer_store_dwordx2 v[20:21], v13, s[52:55], s26 offen sc1
L_k_152:
  s_cbranch_execz L_drest
L_dl2:
  s_cmp_lt_u32 s17, s18
  s_cbranch_scc0 L_drest
  s_mov_b32 m0, s17
  s_add_u32 s17, s17, 1024
  buffer_load_dwordx4 v1, s[44:47], s16 offen nt lds
  s_add_u32 s16, s16, s19
  s_branch L_dl2
L_drest:
  s_cmp_eq_u32 s95, -1
  s_cbranch_scc1 L_noWOc
  s_cbranch_execz L_wo_notr
  s_waitcnt vmcnt(0)
  v_add_u32 v14, s99, v10
  ds_read_b64_tr_b16 v[64:65], v14 offset:0
  ds_read_b64_tr_b16 v[66:67], v14 offset:512
  ds_read_b64_tr_b16 v[68:69], v14 offset:32
  ds_read_b64_tr_b16 v[70:71], v14 offset:544
  ds_read_b64_tr_b16 v[72:73], v14 offset:64
  ds_read_b64_tr_b16 v[74:75], v14 offset:576
  ds_read_b64_tr_b16 v[76:77], v14 offset:96
  ds_read_b64_tr_b16 v[78:79], v14 offset:608
  ds_read_b64_tr_b16 v[80:81], v14 offset:4096
  ds_read_b64_tr_b16 v[82:83], v14 offset:4608
  ds_read_b64_tr_b16 v[84:85], v14 offset:4128
  ds_read_b64_tr_b16 v[86:87], v14 offset:4640
  ds_read_b64_tr_b16 v[88:89], v14 offset:4160
  ds_read_b64_tr_b16 v[90:91], v14 offset:4672
  ds_read_b64_tr_b16 v[92:93], v14 offset:4192
  ds_read_b64_tr_b16 v[94:95], v14 offset:4704
L_wo_notr:
  s_mov_b64 s[66:67], s[42:43]
  s_mov_b64 s[68:69], s[42:43]
  s_mov_b64 s[70:71], s[42:43]
  s_mov_b64 s[72:73], s[42:43]
  s_mov_b64 s[74:75], s[42:43]
  s_mov_b64 s[76:77], s[42:43]
  s_mov_b64 s[78:79], s[42:43]
  s_mov_b64 s[80:81], s[42:43]
  s_mov_b32 s92, 300000
L_g_153:
  s_mov_b64 exec, s[66:67]
  s_cbranch_execz L_gs_155
  buffer_load_dwordx4 v[104:107], v96, s[52:55], 0 offen sc1
L_gs_155:
  s_mov_b64 exec, s[68:69]
  s_cbranch_execz L_gs_156
  buffer_load_dwordx4 v[108:111], v97, s[52:55], 0 offen sc1
L_gs_156:
  s_mov_b64 exec, s[70:71]
  s_cbranch_execz L_gs_157
  buffer_load_dwordx4 v[112:115], v98, s[52:55], 0 offen sc1
L_gs_157:
  s_mov_b64 exec, s[72:73]
  s_cbranch_execz L_gs_158
  buffer_load_dwordx4 v[116:119], v99, s[52:55], 0 offen sc1
L_gs_158:
  s_mov_b64 exec, s[74:75]
  s_cbranch_execz L_gs_159
  buffer_load_dwordx4 v[120:123], v100, s[52:55], 0 offen sc1
L_gs_159:
  s_mov_b64 exec, s[76:77]
  s_cbranch_execz L_gs_160
  buffer_load_dwordx4 v[124:127], v101, s[52:55], 0 offen sc1
L_gs_160:
  s_mov_b64 exec, s[78:79]
  s_cbranch_execz L_gs_161
  buffer_load_dwordx4 v[128:131], v102, s[52:55], 0 offen sc1
L_gs_161:
  s_mov_b64 exec, s[80:81]
  s_cbranch_execz L_gs_162
  buffer_load_dwordx4 v[132:135], v103, s[52:55], 0 offen sc1
L_gs_162:
  s_mov_b64 exec, s[42:43]
  s_waitcnt vmcnt(0)
  v_xor_b32 v16, v3, v105
  v_xor_b32 v17, v3, v107
  v_bitop3_b32 v16, v16, v109, v3 bitop3:0xf6
  v_bitop3_b32 v17, v17, v111, v3 bitop3:0xf6
  v_bitop3_b32 v16, v16, v113, v3 bitop3:0xf6
  v_bitop3_b32 v17, v17, v115, v3 bitop3:0xf6
  v_bitop3_b32 v16, v16, v117, v3 bitop3:0xf6
  v_bitop3_b32 v17, v17, v119, v3 bitop3:0xf6
  v_bitop3_b32 v16, v16, v121, v3 bitop3:0xf6
  v_bitop3_b32 v17, v17, v123, v3 bitop3:0xf6
  v_bitop3_b32 v16, v16, v125, v3 bitop3:0xf6
  v_bitop3_b32 v17, v17, v127, v3 bitop3:0xf6
  v_bitop3_b32 v16, v16, v129, v3 bitop3:0xf6
  v_bitop3_b32 v17, v17, v131, v3 bitop3:0xf6
  v_bitop3_b32 v16, v16, v133, v3 bitop3:0xf6
  v_bitop3_b32 v17, v17, v135, v3 bitop3:0xf6
  v_or_b32 v16, v16, v17
  v_cmp_ne_u32 vcc, 0, v16
  s_cbranch_vccz L_gd_154
  v_cmp_ne_u32 vcc, v3, v105
  v_cmp_ne_u32 s[90:91], v3, v107
  s_nop 1
  s_or_b64 vcc, vcc, s[90:91]
  s_and_b64 s[66:67], s[66:67], vcc
  v_cmp_ne_u32 vcc, v3, v109
  v_cmp_ne_u32 s[90:91], v3, v111
  s_nop 1
  s_or_b64 vcc, vcc, s[90:91]
  s_and_b64 s[68:69], s[68:69], vcc
  v_cmp_ne_u32 vcc, v3, v113
  v_cmp_ne_u32 s[90:91], v3, v115
  s_nop 1
  s_or_b64 vcc, vcc, s[90:91]
  s_and_b64 s[70:71], s[70:71], vcc
  v_cmp_ne_u32 vcc, v3, v117
  v_cmp_ne_u32 s[90:91], v3, v119
  s_nop 1
  s_or_b64 vcc, vcc, s[90:91]
  s_and_b64 s[72:73], s[72:73], vcc
  v_cmp_ne_u32 vcc, v3, v121
  v_cmp_ne_u32 s[90:91], v3, v123
  s_nop 1
  s_or_b64 vcc, vcc, s[90:91]
  s_and_b64 s[74:75], s[74:75], vcc
  v_cmp_ne_u32 vcc, v3, v125
  v_cmp_ne_u32 s[90:91], v3, v127
  s_nop 1
  s_or_b64 vcc, vcc, s[90:91]
  s_and_b64 s[76:77], s[76:77], vcc
  v_cmp_ne_u32 vcc, v3, v129
  v_cmp_ne_u32 s[90:91], v3, v131
  s_nop 1
  s_or_b64 vcc, vcc, s[90:91]
  s_and_b64 s[78:79], s[78:79], vcc
  v_cmp_ne_u32 vcc, v3, v133
  v_cmp_ne_u32 s[90:91], v3, v135
  s_nop 1
  s_or_b64 vcc, vcc, s[90:91]
  s_and_b64 s[80:81], s[80:81], vcc
  s_mov_b64 s[90:91], 0
  s_or_b64 s[90:91], s[90:91], s[66:67]
  s_or_b64 s[90:91], s[90:91], s[68:69]
  s_or_b64 s[90:91], s[90:91], s[70:71]
  s_or_b64 s[90:91], s[90:91], s[72:73]
  s_or_b64 s[90:91], s[90:91], s[74:75]
  s_or_b64 s[90:91], s[90:91], s[76:77]
  s_or_b64 s[90:91], s[90:91], s[78:79]
  s_or_b64 s[90:91], s[90:91], s[80:81]
  s_cbranch_scc0 L_gd_154
  s_sub_u32 s92, s92, 1
  s_cbranch_scc1 L_gd_154
  s_branch L_g_153
L_gd_154:
  s_mov_b64 exec, s[42:43]
  v_permlane32_swap_b32 v104, v108
  v_permlane32_swap_b32 v106, v110
  v_permlane32_swap_b32 v112, v116
  v_permlane32_swap_b32 v114, v118
  v_permlane32_swap_b32 v120, v124
  v_permlane32_swap_b32 v122, v126
  v_permlane32_swap_b32 v128, v132
  v_permlane32_swap_b32 v130, v134
  v_add_f32 v104, v104, v108
  v_add_f32 v106, v106, v110
  v_cvt_pk_bf16_f32 v104, v104, v106
  ds_write_b32 v32, v104 offset:0
  v_add_f32 v112, v112, v116
  v_add_f32 v114, v114, v118
  v_cvt_pk_bf16_f32 v112, v112, v114
  ds_write_b32 v32, v112 offset:320
  v_add_f32 v120, v120, v124
  v_add_f32 v122, v122, v126
  v_cvt_pk_bf16_f32 v120, v120, v122
  ds_write_b32 v32, v120 offset:640
  v_add_f32 v128, v128, v132
  v_add_f32 v130, v130, v134
  v_cvt_pk_bf16_f32 v128, v128, v130
  ds_write_b32 v32, v128 offset:960
  s_waitcnt lgkmcnt(0)
  ds_read_b128 v[136:139], v40
  ds_read_b128 v[140:143], v40 offset:64
  s_waitcnt lgkmcnt(0)
  v_mfma_f32_16x16x32_bf16 v[120:123], v[136:139], v[64:67], 0
  v_mfma_f32_16x16x32_bf16 v[124:127], v[136:139], v[68:71], 0
  v_mfma_f32_16x16x32_bf16 v[128:131], v[136:139], v[72:75], 0
  v_mfma_f32_16x16x32_bf16 v[132:135], v[136:139], v[76:79], 0
  v_mfma_f32_16x16x32_bf16 v[120:123], v[140:143], v[80:83], v[120:123]
  v_mfma_f32_16x16x32_bf16 v[124:127], v[140:143], v[84:87], v[124:127]
  v_mfma_f32_16x16x32_bf16 v[128:131], v[140:143], v[88:91], v[128:131]
  v_mfma_f32_16x16x32_bf16 v[132:135], v[140:143], v[92:95], v[132:135]
  s_mov_b32 exec_hi, 0
  s_nop 3
  ds_write2_b32 v34, v120, v121 offset0:0 offset1:64
  ds_write2_b32 v34, v122, v123 offset0:128 offset1:192
  ds_write2_b32 v34, v124, v125 offset0:16 offset1:80
  ds_write2_b32 v34, v126, v127 offset0:144 offset1:208
  ds_write2_b32 v34, v128, v129 offset0:32 offset1:96
  ds_write2_b32 v34, v130, v131 offset0:160 offset1:224
  ds_write2_b32 v34, v132, v133 offset0:48 offset1:112
  ds_write2_b32 v34, v134, v135 offset0:176 offset1:240
  s_waitcnt lgkmcnt(0)
  s_cbranch_execz L_k_163
  s_barrier
L_k_163:
  ds_read_b128 v[120:123], v35 offset:0
  ds_read_b128 v[124:127], v35 offset:2048
  ds_read_b128 v[128:131], v35 offset:4096
  ds_read_b128 v[132:135], v35 offset:6144
  s_waitcnt lgkmcnt(2)
  v_pk_add_f32 v[120:121], v[120:121], v[124:125]
  v_pk_add_f32 v[122:123], v[122:123], v[126:127]
  s_waitcnt lgkmcnt(0)
  v_pk_add_f32 v[128:129], v[128:129], v[132:133]
  v_pk_add_f32 v[130:131], v[130:131], v[134:135]
  v_pk_add_f32 v[120:121], v[120:121], v[128:129]
  v_pk_add_f32 v[122:123], v[122:123], v[130:131]
  v_add_u32 v136, 0x80, v120
  v_add_u32 v137, 0x80, v121
  v_add_u32 v138, 0x80, v122
  v_add_u32 v139, 0x80, v123
  v_bfi_b32 v136, s9, v36, v136
  v_bfi_b32 v137, s9, v37, v137
  v_bfi_b32 v138, s9, v38, v138
  v_bfi_b32 v139, s9, v39, v139
  s_cbranch_execz L_k_164
  buffer_store_dwordx4 v[136:139], v33, s[52:55], s27 offen sc1
L_k_164:
  s_mov_b64 exec, s[42:43]
L_noWOc:
  s_cmp_eq_u32 s96, -1
  s_cbranch_scc1 L_noB1b
  s_cbranch_execz L_pd_165
  s_mov_b64 s[66:67], -1
  s_mov_b64 s[68:69], -1
  s_mov_b64 s[70:71], -1
  s_mov_b64 s[72:73], -1
  s_mov_b32 s92, 300000
L_p_166:
  s_or_b64 exec, s[66:67], 1
  buffer_load_dwordx4 v[160:163], v144, s[52:55], 0 offen sc1
  s_or_b64 exec, s[68:69], 1
  buffer_load_dwordx4 v[164:167], v145, s[52:55], 0 offen sc1
  s_or_b64 exec, s[70:71], 1
  buffer_load_dwordx4 v[168:171], v146, s[52:55], 0 offen sc1
  s_or_b64 exec, s[72:73], 1
  buffer_load_dwordx4 v[172:175], v147, s[52:55], 0 offen sc1
  s_mov_b64 exec, -1
  s_waitcnt vmcnt(0)
  v_perm_b32 v16, v161, v160, s64
  v_perm_b32 v18, v163, v162, s65
  v_bitop3_b32 v16, v16, v18, v3 bitop3:0x56
  v_cmp_ne_u32 vcc, 0, v16
  v_perm_b32 v17, v165, v164, s64
  v_perm_b32 v19, v167, v166, s65
  v_bitop3_b32 v17, v17, v19, v3 bitop3:0x56
  v_cmp_ne_u32 s[90:91], 0, v17
  s_and_b64 s[66:67], s[66:67], vcc
  s_nop 0
  s_and_b64 s[68:69], s[68:69], s[90:91]
  v_perm_b32 v16, v169, v168, s64
  v_perm_b32 v18, v171, v170, s65
  v_bitop3_b32 v16, v16, v18, v3 bitop3:0x56
  v_cmp_ne_u32 vcc, 0, v16
  v_perm_b32 v17, v173, v172, s64
  v_perm_b32 v19, v175, v174, s65
  v_bitop3_b32 v17, v17, v19, v3 bitop3:0x56
  v_cmp_ne_u32 s[90:91], 0, v17
  s_and_b64 s[70:71], s[70:71], vcc
  s_nop 0
  s_and_b64 s[72:73], s[72:73], s[90:91]
  s_or_b64 s[90:91], s[66:67], s[68:69]
  s_or_b64 s[90:91], s[90:91], s[70:71]
  s_or_b64 s[90:91], s[90:91], s[72:73]
  s_cbranch_scc0 L_pd_165
  s_sub_u32 s92, s92, 1
  s_cbranch_scc0 L_p_166
L_pd_165:
  v_and_b32 v160, 0xffffff00, v160
  v_and_b32 v161, 0xffffff00, v161
  v_and_b32 v162, 0xffffff00, v162
  v_and_b32 v163, 0xffffff00, v163
  v_and_b32 v164, 0xffffff00, v164
  v_and_b32 v165, 0xffffff00, v165
  v_and_b32 v166, 0xffffff00, v166
  v_and_b32 v167, 0xffffff00, v167
  v_and_b32 v168, 0xffffff00, v168
  v_and_b32 v169, 0xffffff00, v169
  v_and_b32 v170, 0xffffff00, v170
  v_and_b32 v171, 0xffffff00, v171
  v_and_b32 v172, 0xffffff00, v172
  v_and_b32 v173, 0xffffff00, v173
  v_and_b32 v174, 0xffffff00, v174
  v_and_b32 v175, 0xffffff00, v175
  v_pk_add_f32 v[120:121], v[160:161], v[164:165]
  v_pk_add_f32 v[122:123], v[162:163], v[166:167]
  v_pk_add_f32 v[124:125], v[168:169], v[172:173]
  v_pk_add_f32 v[126:127], v[170:171], v[174:175]
  v_pk_add_f32 v[120:121], v[120:121], v[124:125]
  v_pk_add_f32 v[122:123], v[122:123], v[126:127]
  s_nop 1
  v_permlane32_swap_b32 v120, v122
  v_permlane32_swap_b32 v121, v123
  v_pk_add_f32 v[120:121], v[120:121], v[122:123]
  s_nop 1
  v_permlane16_swap_b32 v120, v121
  v_add_f32 v120, v120, v121
  v_cvt_pk_bf16_f32 v120, v120, v120
  v_lshlrev_b32 v120, 16, v120
  v_mul_f32 v120, v120, v26
  v_cvt_pk_bf16_f32 v120, v120, v120
  v_lshlrev_b32 v120, 16, v120
  v_add_f32 v120, v120, v28
  v_mov_b32 v121, v120
  v_mov_b32 v125, v3
  s_nop 0
  v_permlane16_swap_b32 v120, v121
  v_cvt_pk_bf16_f32 v124, v120, v121
  s_and_b32 exec_lo, exec_lo, 0xffff
  s_and_b32 exec_hi, exec_hi, 0xffff
  s_cbranch_execz L_k_167
  s_mov_b32 s8, s38
  buffer_store_dwordx2 v[124:125], v31, s[52:55], s8 offen sc1
  s_cmp_eq_u32 s96, 0
  s_cbranch_scc0 L_k_167
  s_mov_b64 exec, 1
  buffer_store_dword v3, v5, s[52:55], 0 offen sc1
L_k_167:
  s_mov_b64 exec, s[42:43]
L_noB1b:
  s_cmp_eq_u32 s98, -1
  s_cbranch_scc1 L_noMc
  s_cbranch_execz L_m_notr
  v_lshlrev_b32 v13, 4, v4
  s_mul_i32 s8, s98, 73728
  s_mul_i32 s9, s3, 18432
  s_add_u32 s8, s8, s9
  s_add_u32 s9, s9, 73728
  s_add_u32 s10, s9, 6144
L_dma_168:
  s_mov_b32 m0, s9
  s_add_u32 s9, s9, 1024
  buffer_load_dwordx4 v13, s[48:51], s8 offen nt lds
  s_add_u32 s8, s8, 1024
  s_cmp_lt_u32 s9, s10
  s_cbranch_scc1 L_dma_168
  s_waitcnt vmcnt(6)
  s_barrier
  s_lshl_b32 s10, s3, 5
  v_add_u32 v14, s10, v10
  v_add_u32 v15, 0x9000, v14
  ds_read_b64_tr_b16 v[112:113], v14 offset:0
  ds_read_b64_tr_b16 v[114:115], v14 offset:512
  s_mov_b32 m0, s9
  s_add_u32 s9, s9, 1024
  buffer_load_dwordx4 v13, s[48:51], s8 offen nt lds
  s_add_u32 s8, s8, 1024
  ds_read_b64_tr_b16 v[116:117], v14 offset:4096
  ds_read_b64_tr_b16 v[118:119], v14 offset:4608
  s_mov_b32 m0, s9
  s_add_u32 s9, s9, 1024
  buffer_load_dwordx4 v13, s[48:51], s8 offen nt lds
  s_add_u32 s8, s8, 1024
  ds_read_b64_tr_b16 v[120:121], v14 offset:8192
  ds_read_b64_tr_b16 v[122:123], v14 offset:8704
  s_mov_b32 m0, s9
  s_add_u32 s9, s9, 1024
  buffer_load_dwordx4 v13, s[48:51], s8 offen nt lds
  s_add_u32 s8, s8, 1024
  ds_read_b64_tr_b16 v[124:125], v14 offset:12288
  ds_read_b64_tr_b16 v[126:127], v14 offset:12800
  s_mov_b32 m0, s9
  s_add_u32 s9, s9, 1024
  buffer_load_dwordx4 v13, s[48:51], s8 offen nt lds
  s_add_u32 s8, s8, 1024
  ds_read_b64_tr_b16 v[128:129], v14 offset:16384
  ds_read_b64_tr_b16 v[130:131], v14 offset:16896
  s_mov_b32 m0, s9
  s_add_u32 s9, s9, 1024
  buffer_load_dwordx4 v13, s[48:51], s8 offen nt lds
  s_add_u32 s8, s8, 1024
  ds_read_b64_tr_b16 v[132:133], v14 offset:20480
  ds_read_b64_tr_b16 v[134:135], v14 offset:20992
  s_mov_b32 m0, s9
  s_add_u32 s9, s9, 1024
  buffer_load_dwordx4 v13, s[48:51], s8 offen nt lds
  s_add_u32 s8, s8, 1024
  ds_read_b64_tr_b16 v[136:137], v14 offset:24576
  ds_read_b64_tr_b16 v[138:139], v14 offset:25088
  s_mov_b32 m0, s9
  s_add_u32 s9, s9, 1024
  buffer_load_dwordx4 v13, s[48:51], s8 offen nt lds
  s_add_u32 s8, s8, 1024
  ds_read_b64_tr_b16 v[140:141], v14 offset:28672
  ds_read_b64_tr_b16 v[142:143], v14 offset:29184
  s_mov_b32 m0, s9
  s_add_u32 s9, s9, 1024
  buffer_load_dwordx4 v13, s[48:51], s8 offen nt lds
  s_add_u32 s8, s8, 1024
  ds_read_b64_tr_b16 v[144:145], v14 offset:32768
  ds_read_b64_tr_b16 v[146:147], v14 offset:33280
  s_mov_b32 m0, s9
  s_add_u32 s9, s9, 1024
  buffer_load_dwordx4 v13, s[48:51], s8 offen nt lds
  s_add_u32 s8, s8, 1024
  ds_read_b64_tr_b16 v[148:149], v15 offset:0
  ds_read_b64_tr_b16 v[150:151], v15 offset:512
  s_mov_b32 m0, s9
  s_add_u32 s9, s9, 1024
  buffer_load_dwordx4 v13, s[48:51], s8 offen nt lds
  s_add_u32 s8, s8, 1024
  ds_read_b64_tr_b16 v[152:153], v15 offset:4096
  ds_read_b64_tr_b16 v[154:155], v15 offset:4608
  s_mov_b32 m0, s9
  s_add_u32 s9, s9, 1024
  buffer_load_dwordx4 v13, s[48:51], s8 offen nt lds
  s_add_u32 s8, s8, 1024
  ds_read_b64_tr_b16 v[156:157], v15 offset:8192
  ds_read_b64_tr_b16 v[158:159], v15 offset:8704
  s_mov_b32 m0, s9
  s_add_u32 s9, s9, 1024
  buffer_load_dwordx4 v13, s[48:51], s8 offen nt lds
  s_add_u32 s8, s8, 1024
  ds_read_b64_tr_b16 v[160:161], v15 offset:12288
  ds_read_b64_tr_b16 v[162:163], v15 offset:12800
  ds_read_b64_tr_b16 v[164:165], v15 offset:16384
  ds_read_b64_tr_b16 v[166:167], v15 offset:16896
  ds_read_b64_tr_b16 v[168:169], v15 offset:20480
  ds_read_b64_tr_b16 v[170:171], v15 offset:20992
  ds_read_b64_tr_b16 v[172:173], v15 offset:24576
  ds_read_b64_tr_b16 v[174:175], v15 offset:25088
  ds_read_b64_tr_b16 v[176:177], v15 offset:28672
  ds_read_b64_tr_b16 v[178:179], v15 offset:29184
  ds_read_b64_tr_b16 v[180:181], v15 offset:32768
  ds_read_b64_tr_b16 v[182:183], v15 offset:33280
  v_mul_u32_u24 v14, 1152, v11
  v_add_u32 v14, v14, v12
  s_mul_i32 s8, s3, 288
  s_add_u32 s8, s8, 73728
  v_add_u32 v14, s8, v14
  s_waitcnt vmcnt(0)
  s_barrier
  ds_read_b64_tr_b16 v[184:185], v14 offset:0
  ds_read_b64_tr_b16 v[186:187], v14 offset:4608
  ds_read_b64_tr_b16 v[188:189], v14 offset:36864
  ds_read_b64_tr_b16 v[190:191], v14 offset:41472
  ds_read_b64_tr_b16 v[192:193], v14 offset:32
  ds_read_b64_tr_b16 v[194:195], v14 offset:4640
  ds_read_b64_tr_b16 v[196:197], v14 offset:36896
  ds_read_b64_tr_b16 v[198:199], v14 offset:41504
  ds_read_b64_tr_b16 v[200:201], v14 offset:64
  ds_read_b64_tr_b16 v[202:203], v14 offset:4672
  ds_read_b64_tr_b16 v[204:205], v14 offset:36928
  ds_read_b64_tr_b16 v[206:207], v14 offset:41536
  ds_read_b64_tr_b16 v[208:209], v14 offset:96
  ds_read_b64_tr_b16 v[210:211], v14 offset:4704
  ds_read_b64_tr_b16 v[212:213], v14 offset:36960
  ds_read_b64_tr_b16 v[214:215], v14 offset:41568
  ds_read_b64_tr_b16 v[216:217], v14 offset:128
  ds_read_b64_tr_b16 v[218:219], v14 offset:4736
  ds_read_b64_tr_b16 v[220:221], v14 offset:36992
  ds_read_b64_tr_b16 v[222:223], v14 offset:41600
  ds_read_b64_tr_b16 v[224:225], v14 offset:160
  ds_read_b64_tr_b16 v[226:227], v14 offset:4768
  ds_read_b64_tr_b16 v[228:229], v14 offset:37024
  ds_read_b64_tr_b16 v[230:231], v14 offset:41632
  ds_read_b64_tr_b16 v[232:233], v14 offset:192
  ds_read_b64_tr_b16 v[234:235], v14 offset:4800
  ds_read_b64_tr_b16 v[236:237], v14 offset:37056
  ds_read_b64_tr_b16 v[238:239], v14 offset:41664
  ds_read_b64_tr_b16 v[240:241], v14 offset:224
  ds_read_b64_tr_b16 v[242:243], v14 offset:4832
  ds_read_b64_tr_b16 v[244:245], v14 offset:37088
  ds_read_b64_tr_b16 v[246:247], v14 offset:41696
  ds_read_b64_tr_b16 v[248:249], v14 offset:256
  ds_read_b64_tr_b16 v[250:251], v14 offset:4864
  ds_read_b64_tr_b16 v[252:253], v14 offset:37120
  ds_read_b64_tr_b16 v[254:255], v14 offset:41728
L_m_notr:
  s_waitcnt lgkmcnt(0)
L_mln:
  s_lshr_b32 s8, s5, 0
  s_lshl_b32 s8, s8, 12
  s_lshl_b32 s10, s94, 8
  s_add_u32 s8, s8, s10
  s_add_u32 s8, s8, 1572864
  s_mov_b32 s64, 0x0c0c0400
  s_mov_b32 s65, 0x04000c0c
  v_mov_b32 v20, 0
  s_cbranch_execz L_pd_169
  s_mov_b64 s[66:67], 1
  s_mov_b32 s92, 300000
L_p_170:
  s_or_b64 exec, s[66:67], 1
  buffer_load_dwordx4 v[104:107], v20, s[52:55], s8 offen sc1
  s_mov_b64 exec, -1
  s_waitcnt vmcnt(0)
  v_perm_b32 v16, v105, v104, s64
  v_perm_b32 v18, v107, v106, s65
  v_bitop3_b32 v16, v16, v18, v3 bitop3:0x56
  v_cmp_ne_u32 vcc, 0, v16
  s_nop 1
  s_and_b64 s[66:67], s[66:67], vcc
  s_cbranch_scc0 L_pd_169
  s_sleep 4
  s_sub_u32 s92, s92, 1
  s_cbranch_scc0 L_p_170
L_pd_169:
  s_cbranch_execz L_pd_171
  s_mov_b64 s[66:67], -1
  s_mov_b64 s[68:69], -1
  s_mov_b64 s[70:71], -1
  s_mov_b64 s[72:73], -1
  s_mov_b32 s74, -1
  s_mov_b32 s75, 0
  s_mov_b32 s92, 300000
L_p_172:
  s_or_b64 exec, s[66:67], 1
  buffer_load_dwordx2 v[76:77], v26, s[52:55], 0 offen offset:0 sc1
  s_or_b64 exec, s[68:69], 1
  buffer_load_dwordx2 v[78:79], v26, s[52:55], 0 offen offset:512 sc1
  s_or_b64 exec, s[70:71], 1
  buffer_load_dwordx2 v[80:81], v26, s[52:55], 0 offen offset:1024 sc1
  s_or_b64 exec, s[72:73], 1
  buffer_load_dwordx2 v[82:83], v26, s[52:55], 0 offen offset:1536 sc1
  s_or_b64 exec, s[74:75], 1
  buffer_load_dwordx2 v[84:85], v26, s[52:55], 0 offen offset:2048 sc1
  s_mov_b64 exec, -1
  s_waitcnt vmcnt(0)
  v_xor_b32 v16, v3, v77
  v_cmp_ne_u32 vcc, 0, v16
  v_xor_b32 v17, v3, v79
  v_cmp_ne_u32 s[90:91], 0, v17
  s_and_b64 s[66:67], s[66:67], vcc
  s_nop 0
  s_and_b64 s[68:69], s[68:69], s[90:91]
  v_xor_b32 v16, v3, v81
  v_cmp_ne_u32 vcc, 0, v16
  v_xor_b32 v17, v3, v83
  v_cmp_ne_u32 s[90:91], 0, v17
  s_and_b64 s[70:71], s[70:71], vcc
  s_nop 0
  s_and_b64 s[72:73], s[72:73], s[90:91]
  v_xor_b32 v16, v3, v85
  v_cmp_ne_u32 vcc, 0, v16
  s_nop 1
  s_and_b64 s[74:75], s[74:75], vcc
  s_or_b64 s[90:91], s[66:67], s[68:69]
  s_or_b64 s[90:91], s[90:91], s[70:71]
  s_or_b64 s[90:91], s[90:91], s[72:73]
  s_or_b64 s[90:91], s[90:91], s[74:75]
  s_cbranch_scc0 L_pd_171
  s_sub_u32 s92, s92, 1
  s_cbranch_scc0 L_p_172
L_pd_171:
  v_lshlrev_b32 v94, 16, v76
  v_and_b32 v95, 0xffff0000, v76
  v_lshlrev_b32 v96, 16, v78
  v_and_b32 v97, 0xffff0000, v78
  v_lshlrev_b32 v98, 16, v80
  v_and_b32 v99, 0xffff0000, v80
  v_lshlrev_b32 v100, 16, v82
  v_and_b32 v101, 0xffff0000, v82
  v_lshlrev_b32 v102, 16, v84
  v_and_b32 v103, 0xffff0000, v84
  v_pk_add_f32 v[16:17], v[94:95], v[96:97]
  v_pk_add_f32 v[18:19], v[98:99], v[100:101]
  v_pk_add_f32 v[16:17], v[16:17], v[102:103]
  v_pk_add_f32 v[16:17], v[16:17], v[18:19]
  v_add_f32 v16, v16, v17
  s_nop 1
  v_add_f32_dpp v16, v16, v16 quad_perm:[1,0,3,2] row_mask:0xf bank_mask:0xf
  s_nop 1
  v_add_f32_dpp v16, v16, v16 quad_perm:[2,3,0,1] row_mask:0xf bank_mask:0xf
  s_nop 1
  v_add_f32_dpp v16, v16, v16 row_half_mirror row_mask:0xf bank_mask:0xf
  s_nop 1
  v_add_f32_dpp v16, v16, v16 row_mirror row_mask:0xf bank_mask:0xf
  v_mov_b32 v17, v16
  s_nop 1
  v_permlane16_swap_b32 v16, v17
  v_add_f32 v16, v16, v17
  v_mov_b32 v17, v16
  s_nop 1
  v_permlane32_swap_b32 v16, v17
  v_add_f32 v16, v16, v17
  v_mul_f32 v16, 987991609, v16
  v_mov_b32 v17, v16
  v_pk_add_f32 v[104:105], v[94:95], v[16:17] neg_lo:[0,1] neg_hi:[0,1]
  v_pk_add_f32 v[106:107], v[96:97], v[16:17] neg_lo:[0,1] neg_hi:[0,1]
  v_pk_add_f32 v[108:109], v[98:99], v[16:17] neg_lo:[0,1] neg_hi:[0,1]
  v_pk_add_f32 v[110:111], v[100:101], v[16:17] neg_lo:[0,1] neg_hi:[0,1]
  v_pk_add_f32 v[20:21], v[102:103], v[16:17] neg_lo:[0,1] neg_hi:[0,1]
  v_pk_mul_f32 v[18:19], v[104:105], v[104:105]
  v_pk_mul_f32 v[22:23], v[106:107], v[106:107]
  v_pk_fma_f32 v[18:19], v[108:109], v[108:109], v[18:19]
  v_pk_fma_f32 v[22:23], v[110:111], v[110:111], v[22:23]
  s_mov_b32 exec_hi, 0
  v_pk_fma_f32 v[18:19], v[20:21], v[20:21], v[18:19]
  s_mov_b64 exec, s[42:43]
  v_pk_add_f32 v[18:19], v[18:19], v[22:23]
  v_add_f32 v18, v18, v19
  s_nop 1
  v_add_f32_dpp v18, v18, v18 quad_perm:[1,0,3,2] row_mask:0xf bank_mask:0xf
  s_nop 1
  v_add_f32_dpp v18, v18, v18 quad_perm:[2,3,0,1] row_mask:0xf bank_mask:0xf
  s_nop 1
  v_add_f32_dpp v18, v18, v18 row_half_mirror row_mask:0xf bank_mask:0xf
  s_nop 1
  v_add_f32_dpp v18, v18, v18 row_mirror row_mask:0xf bank_mask:0xf
  v_mov_b32 v19, v18
  s_nop 1
  v_permlane16_swap_b32 v18, v19
  v_add_f32 v18, v18, v19
  v_mov_b32 v19, v18
  s_nop 1
  v_permlane32_swap_b32 v18, v19
  v_add_f32 v18, v18, v19
  v_mul_f32 v18, 987991609, v18
  v_cvt_pk_bf16_f32 v18, v18, v18
  v_lshlrev_b32 v18, 16, v18
  v_cvt_pk_bf16_f32 v16, v16, v16
  v_lshlrev_b32 v16, 16, v16
  v_add_f32 v18, 925353388, v18
  v_cvt_pk_bf16_f32 v18, v18, v18
  v_lshlrev_b32 v18, 16, v18
  v_sqrt_f32 v18, v18
  s_nop 0
  v_cvt_pk_bf16_f32 v18, v18, v18
  v_lshlrev_b32 v18, 16, v18
  v_rcp_f32 v18, v18
  v_mov_b32 v17, v16
  v_mov_b32 v19, v18
  v_pk_add_f32 v[94:95], v[94:95], v[16:17] neg_lo:[0,1] neg_hi:[0,1]
  v_pk_add_f32 v[96:97], v[96:97], v[16:17] neg_lo:[0,1] neg_hi:[0,1]
  v_pk_add_f32 v[98:99], v[98:99], v[16:17] neg_lo:[0,1] neg_hi:[0,1]
  v_pk_add_f32 v[100:101], v[100:101], v[16:17] neg_lo:[0,1] neg_hi:[0,1]
  v_pk_add_f32 v[102:103], v[102:103], v[16:17] neg_lo:[0,1] neg_hi:[0,1]
  v_cvt_pk_bf16_f32 v94, v94, v95
  v_cvt_pk_bf16_f32 v96, v96, v97
  v_cvt_pk_bf16_f32 v98, v98, v99
  v_cvt_pk_bf16_f32 v100, v100, v101
  v_cvt_pk_bf16_f32 v102, v102, v103
  v_and_b32 v95, 0xffff0000, v94
  v_lshlrev_b32 v94, 16, v94
  v_and_b32 v97, 0xffff0000, v96
  v_lshlrev_b32 v96, 16, v96
  v_and_b32 v99, 0xffff0000, v98
  v_lshlrev_b32 v98, 16, v98
  v_and_b32 v101, 0xffff0000, v100
  v_lshlrev_b32 v100, 16, v100
  v_and_b32 v103, 0xffff0000, v102
  v_lshlrev_b32 v102, 16, v102
  v_pk_mul_f32 v[94:95], v[94:95], v[18:19]
  v_pk_mul_f32 v[96:97], v[96:97], v[18:19]
  v_pk_mul_f32 v[98:99], v[98:99], v[18:19]
  v_pk_mul_f32 v[100:101], v[100:101], v[18:19]
  v_pk_mul_f32 v[102:103], v[102:103], v[18:19]
  v_cvt_pk_bf16_f32 v94, v94, v95
  v_cvt_pk_bf16_f32 v96, v96, v97
  v_cvt_pk_bf16_f32 v98, v98, v99
  v_cvt_pk_bf16_f32 v100, v100, v101
  v_cvt_pk_bf16_f32 v102, v102, v103
  v_and_b32 v95, 0xffff0000, v94
  v_lshlrev_b32 v94, 16, v94
  v_and_b32 v97, 0xffff0000, v96
  v_lshlrev_b32 v96, 16, v96
  v_and_b32 v99, 0xffff0000, v98
  v_lshlrev_b32 v98, 16, v98
  v_and_b32 v101, 0xffff0000, v100
  v_lshlrev_b32 v100, 16, v100
  v_and_b32 v103, 0xffff0000, v102
  v_lshlrev_b32 v102, 16, v102
  v_pk_mul_f32 v[94:95], v[94:95], v[58:59]
  v_pk_mul_f32 v[96:97], v[96:97], v[60:61]
  v_pk_mul_f32 v[98:99], v[98:99], v[62:63]
  v_pk_mul_f32 v[100:101], v[100:101], v[64:65]
  v_pk_mul_f32 v[102:103], v[102:103], v[66:67]
  v_cvt_pk_bf16_f32 v94, v94, v95
  v_cvt_pk_bf16_f32 v96, v96, v97
  v_cvt_pk_bf16_f32 v98, v98, v99
  v_cvt_pk_bf16_f32 v100, v100, v101
  v_cvt_pk_bf16_f32 v102, v102, v103
  v_and_b32 v95, 0xffff0000, v94
  v_lshlrev_b32 v94, 16, v94
  v_and_b32 v97, 0xffff0000, v96
  v_lshlrev_b32 v96, 16, v96
  v_and_b32 v99, 0xffff0000, v98
  v_lshlrev_b32 v98, 16, v98
  v_and_b32 v101, 0xffff0000, v100
  v_lshlrev_b32 v100, 16, v100
  v_and_b32 v103, 0xffff0000, v102
  v_lshlrev_b32 v102, 16, v102
  v_pk_add_f32 v[94:95], v[94:95], v[40:41]
  v_pk_add_f32 v[96:97], v[96:97], v[42:43]
  v_pk_add_f32 v[98:99], v[98:99], v[44:45]
  v_pk_add_f32 v[100:101], v[100:101], v[46:47]
  v_pk_add_f32 v[102:103], v[102:103], v[48:49]
  v_cvt_pk_bf16_f32 v94, v94, v95
  ds_write_b32 v27, v94 offset:0
  v_cvt_pk_bf16_f32 v96, v96, v97
  ds_write_b32 v27, v96 offset:256
  v_cvt_pk_bf16_f32 v98, v98, v99
  ds_write_b32 v27, v98 offset:512
  v_cvt_pk_bf16_f32 v100, v100, v101
  ds_write_b32 v27, v100 offset:768
  v_cvt_pk_bf16_f32 v102, v102, v103
  s_mov_b32 exec_hi, 0
  ds_write_b32 v27, v102 offset:1024
  s_mov_b64 exec, s[42:43]
  s_waitcnt lgkmcnt(0)
  s_cbranch_execz L_k_173
  s_barrier
L_k_173:
  s_cmp_ge_u32 s94, 4
  s_cbranch_scc1 L_end
  ds_read_b128 v[40:43], v28 offset:0
  ds_read_b128 v[44:47], v28 offset:64
  ds_read_b128 v[48:51], v28 offset:128
  ds_read_b128 v[52:55], v28 offset:192
  ds_read_b128 v[56:59], v28 offset:256
  ds_read_b128 v[60:63], v28 offset:320
  ds_read_b128 v[64:67], v28 offset:384
  ds_read_b128 v[68:71], v28 offset:448
  ds_read_b128 v[72:75], v9 offset:1024
  s_waitcnt lgkmcnt(8)
  v_mfma_f32_16x16x32_bf16 v[16:19], v[40:43], v[112:115], 0
  v_mfma_f32_16x16x32_bf16 v[20:23], v[40:43], v[144:147], 0
  s_waitcnt lgkmcnt(7)
  v_mfma_f32_16x16x32_bf16 v[16:19], v[44:47], v[116:119], v[16:19]
  v_mfma_f32_16x16x32_bf16 v[20:23], v[44:47], v[148:151], v[20:23]
  s_waitcnt lgkmcnt(6)
  v_mfma_f32_16x16x32_bf16 v[16:19], v[48:51], v[120:123], v[16:19]
  v_mfma_f32_16x16x32_bf16 v[20:23], v[48:51], v[152:155], v[20:23]
  s_waitcnt lgkmcnt(5)
  v_mfma_f32_16x16x32_bf16 v[16:19], v[52:55], v[124:127], v[16:19]
  v_mfma_f32_16x16x32_bf16 v[20:23], v[52:55], v[156:159], v[20:23]
  s_waitcnt lgkmcnt(4)
  v_mfma_f32_16x16x32_bf16 v[16:19], v[56:59], v[128:131], v[16:19]
  v_mfma_f32_16x16x32_bf16 v[20:23], v[56:59], v[160:163], v[20:23]
  s_waitcnt lgkmcnt(3)
  v_mfma_f32_16x16x32_bf16 v[16:19], v[60:63], v[132:135], v[16:19]
  v_mfma_f32_16x16x32_bf16 v[20:23], v[60:63], v[164:167], v[20:23]
  s_waitcnt lgkmcnt(2)
  v_mfma_f32_16x16x32_bf16 v[16:19], v[64:67], v[136:139], v[16:19]
  v_mfma_f32_16x16x32_bf16 v[20:23], v[64:67], v[168:171], v[20:23]
  s_waitcnt lgkmcnt(1)
  v_mfma_f32_16x16x32_bf16 v[16:19], v[68:71], v[140:143], v[16:19]
  v_mfma_f32_16x16x32_bf16 v[20:23], v[68:71], v[172:175], v[20:23]
  s_waitcnt lgkmcnt(0)
  v_mfma_f32_16x16x32_bf16 v[16:19], v[72:75], v[176:179], v[16:19]
  v_mfma_f32_16x16x32_bf16 v[20:23], v[72:75], v[180:183], v[20:23]
  s_nop 7
  v_permlane32_swap_b32 v20, v76
  v_permlane32_swap_b32 v21, v77
  v_permlane32_swap_b32 v22, v78
  v_permlane32_swap_b32 v23, v79
  v_pk_add_f32 v[16:17], v[16:17], v[76:77]
  v_pk_add_f32 v[18:19], v[18:19], v[78:79]
  v_max_f32 v16, 0, v16
  v_max_f32 v17, 0, v17
  v_max_f32 v18, 0, v18
  v_max_f32 v19, 0, v19
  v_cvt_pk_bf16_f32 v16, v16, v16
  v_cvt_pk_bf16_f32 v17, v17, v17
  v_cvt_pk_bf16_f32 v18, v18, v18
  v_cvt_pk_bf16_f32 v19, v19, v19
  s_mov_b32 exec_hi, 0
  ds_write_b16 v30, v16 offset:0
  ds_write_b16 v30, v17 offset:160
  ds_write_b16 v30, v18 offset:320
  ds_write_b16 v30, v19 offset:480
  s_mov_b64 exec, s[42:43]
  s_mov_b32 s9, 0xff
  s_add_u32 s8, s39, 4096
  s_waitcnt lgkmcnt(0)
  s_cbranch_execz L_k_174
  s_barrier
L_k_174:
  ds_read_b128 v[76:79], v31
  ds_read_b128 v[80:83], v32
  ds_read_b128 v[84:87], v33 offset:64
  ds_read_b128 v[88:91], v34 offset:64
  s_waitcnt lgkmcnt(3)
  v_mfma_f32_16x16x32_bf16 v[92:95], v[76:79], v[184:187], 0
  s_waitcnt lgkmcnt(2)
  v_mfma_f32_16x16x32_bf16 v[92:95], v[80:83], v[192:195], v[92:95]
  s_waitcnt lgkmcnt(1)
  v_mfma_f32_16x16x32_bf16 v[92:95], v[84:87], v[188:191], v[92:95]
  s_waitcnt lgkmcnt(0)
  v_mfma_f32_16x16x32_bf16 v[92:95], v[88:91], v[196:199], v[92:95]
  v_mfma_f32_16x16x32_bf16 v[96:99], v[76:79], v[200:203], 0
  v_mfma_f32_16x16x32_bf16 v[96:99], v[80:83], v[208:211], v[96:99]
  v_mfma_f32_16x16x32_bf16 v[96:99], v[84:87], v[204:207], v[96:99]
  v_mfma_f32_16x16x32_bf16 v[96:99], v[88:91], v[212:215], v[96:99]
  v_mfma_f32_16x16x32_bf16 v[100:103], v[76:79], v[216:219], 0
  v_mfma_f32_16x16x32_bf16 v[100:103], v[80:83], v[224:227], v[100:103]
  v_mfma_f32_16x16x32_bf16 v[100:103], v[84:87], v[220:223], v[100:103]
  v_mfma_f32_16x16x32_bf16 v[100:103], v[88:91], v[228:231], v[100:103]
  v_bfi_b32 v92, s9, v36, v92
  v_bfi_b32 v93, s9, v37, v93
  v_bfi_b32 v94, s9, v38, v94
  v_bfi_b32 v95, s9, v39, v95
  s_cbranch_execz L_k_175
  buffer_store_dwordx4 v[92:95], v35, s[52:55], s39 offen offset:0 sc1
L_k_175:
  v_mfma_f32_16x16x32_bf16 v[104:107], v[76:79], v[232:235], 0
  v_mfma_f32_16x16x32_bf16 v[104:107], v[80:83], v[240:243], v[104:107]
  v_mfma_f32_16x16x32_bf16 v[104:107], v[84:87], v[236:239], v[104:107]
  v_mfma_f32_16x16x32_bf16 v[104:107], v[88:91], v[244:247], v[104:107]
  v_bfi_b32 v96, s9, v36, v96
  v_bfi_b32 v97, s9, v37, v97
  v_bfi_b32 v98, s9, v38, v98
  v_bfi_b32 v99, s9, v39, v99
  s_cbranch_execz L_k_176
  buffer_store_dwordx4 v[96:99], v35, s[52:55], s39 offen offset:1024 sc1
L_k_176:
  v_mfma_f32_16x16x32_bf16 v[108:111], v[76:79], v[248:251], 0
  v_mfma_f32_16x16x32_bf16 v[108:111], v[84:87], v[252:255], v[108:111]
  v_bfi_b32 v100, s9, v36, v100
  v_bfi_b32 v101, s9, v37, v101
  v_bfi_b32 v102, s9, v38, v102
  v_bfi_b32 v103, s9, v39, v103
  s_cbranch_execz L_k_177
  buffer_store_dwordx4 v[100:103], v35, s[52:55], s39 offen offset:2048 sc1
L_k_177:
  v_bfi_b32 v104, s9, v36, v104
  v_bfi_b32 v105, s9, v37, v105
  v_bfi_b32 v106, s9, v38, v106
  v_bfi_b32 v107, s9, v39, v107
  s_cbranch_execz L_k_178
  buffer_store_dwordx4 v[104:107], v35, s[52:55], s39 offen offset:3072 sc1
L_k_178:
  v_bfi_b32 v108, s9, v36, v108
  v_bfi_b32 v109, s9, v37, v109
  v_bfi_b32 v110, s9, v38, v110
  v_bfi_b32 v111, s9, v39, v111
  s_mov_b32 exec_hi, 0
  s_cbranch_execz L_k_179
  buffer_store_dwordx4 v[108:111], v35, s[52:55], s8 offen offset:0 sc1
L_k_179:
  s_mov_b64 exec, s[42:43]
  s_cmp_eq_u32 s3, 0
  s_cbranch_scc0 L_k_180
  s_cbranch_execz L_k_180
  s_lshl_b32 s10, s98, 7
  s_add_u32 s10, s10, 1015808
  s_mov_b64 exec, 1
  buffer_store_dword v3, v5, s[52:55], s10 offen sc1
  s_mov_b64 exec, -1
L_k_180:
L_noMc:
  s_cmp_eq_u32 s97, -1
  s_cbranch_scc1 L_noDb
  v_mov_b32 v176, 0
  v_mov_b32 v177, 0
  v_mov_b32 v178, 0
  v_mov_b32 v179, 0
  s_mul_i32 s10, s97, 57
  s_lshr_b32 s10, s10, 12
  s_mul_i32 s10, s10, 72
  s_sub_u32 s10, s97, s10
  s_lshl_b32 s10, s10, 7
  s_add_u32 s10, s10, 1015808
  s_cbranch_execz L_pd_181
  s_mov_b64 s[66:67], 1
  s_mov_b32 s92, 300000
L_p_182:
  s_or_b64 exec, s[66:67], 1
  buffer_load_dword v31, v5, s[52:55], s10 offen sc1
  s_mov_b64 exec, -1
  s_waitcnt vmcnt(0)
  v_xor_b32 v16, v3, v31
  v_cmp_ne_u32 vcc, 0, v16
  s_nop 1
  s_and_b64 s[66:67], s[66:67], vcc
  s_cbranch_scc0 L_pd_181
  s_sub_u32 s92, s92, 1
  s_cbranch_scc0 L_p_182
L_pd_181:
  s_cbranch_execz L_pd_183
  s_mov_b64 s[66:67], -1
  s_mov_b64 s[68:69], -1
  s_mov_b64 s[70:71], -1
  s_mov_b64 s[72:73], -1
  s_mov_b32 s74, -1
  s_mov_b32 s75, 0
  s_mov_b64 s[76:77], 0xffff
  s_mov_b32 s92, 300000
L_p_184:
  s_or_b64 exec, s[66:67], 1
  buffer_load_dwordx4 v[160:163], v144, s[52:55], 0 offen sc1
  s_or_b64 exec, s[68:69], 1
  buffer_load_dwordx4 v[164:167], v145, s[52:55], 0 offen sc1
  s_or_b64 exec, s[70:71], 1
  buffer_load_dwordx4 v[168:171], v146, s[52:55], 0 offen sc1
  s_or_b64 exec, s[72:73], 1
  buffer_load_dwordx4 v[172:175], v147, s[52:55], 0 offen sc1
  s_or_b64 exec, s[74:75], 1
  buffer_load_dwordx4 v[176:179], v148, s[52:55], 0 offen sc1
  s_or_b64 exec, s[76:77], 1
  buffer_load_dwordx2 v[30:31], v27, s[52:55], 0 offen sc1
  s_mov_b64 exec, -1
  s_waitcnt vmcnt(0)
  v_perm_b32 v16, v161, v160, s64
  v_perm_b32 v18, v163, v162, s65
  v_bitop3_b32 v16, v16, v18, v3 bitop3:0x56
  v_cmp_ne_u32 vcc, 0, v16
  v_perm_b32 v17, v165, v164, s64
  v_perm_b32 v19, v167, v166, s65
  v_bitop3_b32 v17, v17, v19, v3 bitop3:0x56
  v_cmp_ne_u32 s[90:91], 0, v17
  s_and_b64 s[66:67], s[66:67], vcc
  s_nop 0
  s_and_b64 s[68:69], s[68:69], s[90:91]
  v_perm_b32 v16, v169, v168, s64
  v_perm_b32 v18, v171, v170, s65
  v_bitop3_b32 v16, v16, v18, v3 bitop3:0x56
  v_cmp_ne_u32 vcc, 0, v16
  v_perm_b32 v17, v173, v172, s64
  v_perm_b32 v19, v175, v174, s65
  v_bitop3_b32 v17, v17, v19, v3 bitop3:0x56
  v_cmp_ne_u32 s[90:91], 0, v17
  s_and_b64 s[70:71], s[70:71], vcc
  s_nop 0
  s_and_b64 s[72:73], s[72:73], s[90:91]
  v_perm_b32 v16, v177, v176, s64
  v_perm_b32 v18, v179, v178, s65
  v_bitop3_b32 v16, v16, v18, v3 bitop3:0x56
  v_cmp_ne_u32 vcc, 0, v16
  v_xor_b32 v17, v3, v31
  v_cmp_ne_u32 s[90:91], 0, v17
  s_and_b64 s[74:75], s[74:75], vcc
  s_nop 0
  s_and_b64 s[76:77], s[76:77], s[90:91]
  s_or_b64 s[90:91], s[66:67], s[68:69]
  s_or_b64 s[90:91], s[90:91], s[70:71]
  s_or_b64 s[90:91], s[90:91], s[72:73]
  s_or_b64 s[90:91], s[90:91], s[74:75]
  s_or_b64 s[90:91], s[90:91], s[76:77]
  s_cbranch_scc0 L_pd_183
  s_sub_u32 s92, s92, 1
  s_cbranch_scc0 L_p_184
L_pd_183:
  v_cmp_eq_u32 vcc, 0, v29
  v_lshlrev_b32 v16, 16, v30
  v_and_b32 v17, 0xffff0000, v30
  v_cndmask_b32 v30, v17, v16, vcc
  v_and_b32 v160, 0xffffff00, v160
  v_and_b32 v161, 0xffffff00, v161
  v_and_b32 v162, 0xffffff00, v162
  v_and_b32 v163, 0xffffff00, v163
  v_and_b32 v164, 0xffffff00, v164
  v_and_b32 v165, 0xffffff00, v165
  v_and_b32 v166, 0xffffff00, v166
  v_and_b32 v167, 0xffffff00, v167
  v_and_b32 v168, 0xffffff00, v168
  v_and_b32 v169, 0xffffff00, v169
  v_and_b32 v170, 0xffffff00, v170
  v_and_b32 v171, 0xffffff00, v171
  v_and_b32 v172, 0xffffff00, v172
  v_and_b32 v173, 0xffffff00, v173
  v_and_b32 v174, 0xffffff00, v174
  v_and_b32 v175, 0xffffff00, v175
  v_and_b32 v176, 0xffffff00, v176
  v_and_b32 v177, 0xffffff00, v177
  v_and_b32 v178, 0xffffff00, v178
  v_and_b32 v179, 0xffffff00, v179
  v_pk_add_f32 v[108:109], v[160:161], v[164:165]
  v_pk_add_f32 v[116:117], v[168:169], v[172:173]
  v_pk_add_f32 v[110:111], v[162:163], v[166:167]
  v_pk_add_f32 v[118:119], v[170:171], v[174:175]
  v_pk_add_f32 v[108:109], v[108:109], v[176:177]
  v_pk_add_f32 v[110:111], v[110:111], v[178:179]
  v_pk_add_f32 v[108:109], v[108:109], v[116:117]
  v_pk_add_f32 v[110:111], v[110:111], v[118:119]
  s_nop 0
  v_add_f32_dpp v108, v108, v108 row_ror:8 row_mask:0xf bank_mask:0xf
  v_add_f32_dpp v109, v109, v109 row_ror:8 row_mask:0xf bank_mask:0xf
  v_add_f32_dpp v110, v110, v110 row_ror:8 row_mask:0xf bank_mask:0xf
  v_add_f32_dpp v111, v111, v111 row_ror:8 row_mask:0xf bank_mask:0xf
  v_add_f32_dpp v108, v108, v108 row_ror:4 row_mask:0xf bank_mask:0xf
  v_add_f32_dpp v109, v109, v109 row_ror:4 row_mask:0xf bank_mask:0xf
  v_add_f32_dpp v110, v110, v110 row_ror:4 row_mask:0xf bank_mask:0xf
  v_add_f32_dpp v111, v111, v111 row_ror:4 row_mask:0xf bank_mask:0xf
  s_mov_b32 s10, 0x00f000f0
  s_mov_b32 s11, 0x00f000f0
  s_mov_b32 s12, 0xf000f000
  s_mov_b32 s13, 0xf000f000
  s_mov_b32 s14, 0xff00ff00
  s_mov_b32 s15, 0xff00ff00
  v_cndmask_b32 v108, v108, v109, s[10:11]
  v_cndmask_b32 v110, v110, v111, s[12:13]
  v_cndmask_b32 v108, v108, v110, s[14:15]
  v_mov_b32 v109, v108
  s_nop 1
  v_permlane16_swap_b32 v108, v109
  v_add_f32 v108, v108, v109
  v_mov_b32 v109, v108
  s_nop 1
  v_permlane32_swap_b32 v108, v109
  v_add_f32 v108, v108, v109
  v_cvt_pk_bf16_f32 v108, v108, v108
  v_lshlrev_b32 v108, 16, v108
  v_mul_f32 v108, v108, v26
  v_cvt_pk_bf16_f32 v108, v108, v108
  v_lshlrev_b32 v108, 16, v108
  v_add_f32 v108, v108, v30
  v_cvt_pk_bf16_f32 v108, v108, v108
  s_and_b32 exec_lo, exec_lo, 0xffff
  s_mov_b32 exec_hi, 0
  s_cbranch_execz L_k_185
  buffer_store_short v108, v28, s[60:63], 0 offen
L_k_185:
  s_mov_b64 exec, s[42:43]
L_noDb:
  s_cmp_eq_u32 s42, 0
  s_cbranch_scc0 L_fin
  s_mov_b64 s[42:43], -1
  s_mov_b64 exec, -1
  v_mov_b32 v21, v3
  s_branch L_be
L_fin:
L_end:
  s_endpgm
.section .rodata,"a"
.p2align 6
.amdhsa_kernel adaLN_cond__gqa_block_cached__dense_activation_relu__decode_kernel
  .amdhsa_next_free_vgpr 256
  .amdhsa_next_free_sgpr 102
  .amdhsa_accum_offset 256
  .amdhsa_group_segment_fixed_size 0
  .amdhsa_kernarg_size 104
  .amdhsa_user_sgpr_count 2
  .amdhsa_user_sgpr_kernarg_segment_ptr 1
  .amdhsa_system_sgpr_workgroup_id_x 1
.end_amdhsa_kernel
```
